```python
import torch

def _softmax(x, axis=-1):
    return torch.softmax(x, dim=axis)
def _gelu(x):
    return torch.nn.functional.gelu(x, approximate="tanh")
def _silu(x):
    return torch.nn.functional.silu(x)
def _sigmoid(x):
    return torch.sigmoid(x)
def _layernorm(x, axis=-1, eps=1e-5):
    m = x.mean(dim=axis, keepdim=True)
    v = x.var(dim=axis, keepdim=True, unbiased=False)
    return (x - m) / torch.sqrt(v + eps)
def _scatter_add(tgt, idx, src, axis=0):
    return tgt.clone().index_add_(axis, idx, src)
def _segment_sum(src, seg, n):
    out = torch.zeros((n,) + src.shape[1:], dtype=src.dtype)
    return out.index_add_(0, seg, src)
def _pad(x, pw):
    flat = tuple(v for pair in reversed(pw) for v in pair)
    return torch.nn.functional.pad(x, flat)

kernel_name = 'parallel_sum__ssm_conv_s5__mixer_token_mlp__prompt'

def setup_inputs():

    _w = (lambda a: (lambda t: t.to(torch.bfloat16) if t.is_floating_point() else t)(torch.as_tensor(a)))
    def _A_setup():
        B, S, D = 1, 2048, 448
        P = D
        Lambda_re = -0.5 * (lambda _x: torch.exp(torch.as_tensor(_x)))((lambda *s: torch.randn(*s, dtype=torch.bfloat16) * 0.1)(P))
        Lambda_im = (lambda *s: torch.randn(*s, dtype=torch.bfloat16) * 0.4)(P) * 1.0
        B_re = (lambda *s: torch.randn(*s, dtype=torch.bfloat16) * 0.2)(P, D) * (D ** -0.5)
        B_im = (lambda *s: torch.randn(*s, dtype=torch.bfloat16) * 0.2)(P, D) * (D ** -0.5)
        C_re = (lambda *s: torch.randn(*s, dtype=torch.bfloat16) * 0.2)(D, P) * (P ** -0.5)
        C_im = (lambda *s: torch.randn(*s, dtype=torch.bfloat16) * 0.2)(D, P) * (P ** -0.5)
        log_dt = (lambda *s: torch.randn(*s, dtype=torch.bfloat16) * 0.1)(P) * 0.3 - 2.0
        Dskip = (lambda *s: torch.randn(*s, dtype=torch.bfloat16) * 0.05)(D)
        return {
            "x": _w((lambda *s: torch.randn(*s, dtype=torch.bfloat16) * 0.05)(B, S, D)),
            "Lambda_re": _w(Lambda_re),
            "Lambda_im": _w(Lambda_im),
            "B_re": _w(B_re),
            "B_im": _w(B_im),
            "C_re": _w(C_re),
            "C_im": _w(C_im),
            "log_dt": _w(log_dt),
            "Dskip": _w(Dskip),
        }
    _A_in = _A_setup()

    def _B_setup():
        B, S, D, F = 1, 2048, 448, 1792
        return {
            "x": _w((lambda *s: torch.randn(*s, dtype=torch.bfloat16) * 0.05)(B, S, D)),
            "w1": _w((lambda *s: torch.randn(*s, dtype=torch.bfloat16) * 0.8)(S, F) * (S ** -0.5)),
            "b1": _w((lambda *s: torch.randn(*s, dtype=torch.bfloat16) * 3.2)(F) * 0.02),
            "w2": _w((lambda *s: torch.randn(*s, dtype=torch.bfloat16) * 0.4)(F, S) * (F ** -0.5)),
            "b2": _w((lambda *s: torch.randn(*s, dtype=torch.bfloat16) * 1.6)(S) * 0.02),
        }
    _B_in = _B_setup()

    return {
        "A_x": _A_in["x"],
        "A_Lambda_re": _A_in["Lambda_re"],
        "A_Lambda_im": _A_in["Lambda_im"],
        "A_B_re": _A_in["B_re"],
        "A_B_im": _A_in["B_im"],
        "A_C_re": _A_in["C_re"],
        "A_C_im": _A_in["C_im"],
        "A_log_dt": _A_in["log_dt"],
        "A_Dskip": _A_in["Dskip"],
        "B_x": _B_in["x"],
        "B_w1": _B_in["w1"],
        "B_b1": _B_in["b1"],
        "B_w2": _B_in["w2"],
        "B_b2": _B_in["b2"],
    }

def reference(A_x, A_Lambda_re, A_Lambda_im, A_B_re, A_B_im, A_C_re, A_C_im, A_log_dt, A_Dskip, B_x, B_w1, B_b1, B_w2, B_b2):
    def _A_ref(x, Lambda_re, Lambda_im, B_re, B_im, C_re, C_im, log_dt, Dskip):
        Bsz, L, H = x.shape
        Lam = Lambda_re + 1j * Lambda_im
        Bmat = B_re + 1j * B_im
        Cmat = C_re + 1j * C_im
        dt = torch.exp(log_dt)
        Lam_bar = torch.exp(dt * Lam)
        B_bar = ((Lam_bar - 1.0) / Lam)[:, None] * Bmat
        Bu = torch.einsum("bld,pd->blp", x + 0j, B_bar)
        h = torch.zeros_like(Bu[:, 0, :])
        hs = []
        for t in range(L):
            h = Lam_bar[None, :] * h + Bu[:, t, :]
            hs.append(h)
        hseq = torch.stack(hs, 1)
        y = 2.0 * torch.einsum("blp,dp->bld", hseq, Cmat).real + x * Dskip[None, None, :]
        return y

    def _B_ref(x, w1, b1, w2, b2):
        B, S, D = x.shape
        h = _layernorm(x, axis=-1)
        u = torch.einsum("bsd,sf->bdf", h, w1) + b1
        u = _gelu(u)
        y = torch.einsum("bdf,fs->bds", u, w2) + b2
        return (lambda x, *d: x.permute(*d))(y, 0, 2, 1)

    x = A_x
    xn = _layernorm(x, axis=-1)
    return x + _A_ref(xn, A_Lambda_re, A_Lambda_im, A_B_re, A_B_im, A_C_re, A_C_im, A_log_dt, A_Dskip) + _B_ref(xn, B_w1, B_b1, B_w2, B_b2)
```

```asm
; @launch grid=(256,1,1) block=(256,1,1) lds=163840
.amdgcn_target "amdgcn-amd-amdhsa--gfx950"
.text
.globl parallel_sum__ssm_conv_s5__mixer_token_mlp__prompt_kernel
.p2align 8
.type parallel_sum__ssm_conv_s5__mixer_token_mlp__prompt_kernel,@function
parallel_sum__ssm_conv_s5__mixer_token_mlp__prompt_kernel:
  s_cmp_ge_u32 s2, 256
  s_cbranch_scc1 L_exit
  s_load_dwordx16 s[4:19], s[0:1], 0
  s_load_dwordx2 s[20:21], s[0:1], 64
  s_load_dwordx8 s[24:31], s[0:1], 80
  s_load_dwordx4 s[32:35], s[0:1], 112
  s_load_dwordx2 s[36:37], s[0:1], 128
  v_lshrrev_b32 v7, 6, v0
  v_and_b32 v0, 63, v0
  v_readfirstlane_b32 s64, v7
  v_lshlrev_b32 v1, 4, v0
  s_mov_b32 s72, 0xffff0000
  s_mov_b32 s73, 0x3f803f80
  s_and_b32 s22, s2, 7
  s_lshr_b32 s23, s2, 3
  s_and_b32 s38, s22, 1
  s_lshr_b32 s39, s22, 1
  s_lshr_b32 s65, s64, 1
  s_and_b32 s66, s64, 1
  s_mul_i32 s79, s23, 37
  s_lshr_b32 s79, s79, 8
  s_mul_i32 s80, s79, 7
  s_sub_u32 s68, s23, s80
  s_mov_b32 s69, s68
  s_lshl_b32 s80, s22, 2
  s_add_u32 s67, s80, s79
  s_min_u32 s67, s67, 31
  s_mul_i32 s80, s39, 7
  s_lshl_b32 s81, s38, 2
  s_add_u32 s87, s80, s81
  s_add_u32 s70, s87, s79
  s_min_u32 s70, s70, 27
  s_lshl_b32 s81, s38, 2
  s_add_u32 s69, s81, s79
  s_min_u32 s69, s69, 6
  s_mul_i32 s87, s39, 7
  s_add_u32 s70, s87, s68
  s_sub_u32 s80, 4, s38
  s_cmp_lt_u32 s79, s80
  s_cselect_b32 s71, 1, 0
  s_cmp_lt_u32 s23, 28
  s_cselect_b32 s74, 1, 0
  s_waitcnt lgkmcnt(0)
  s_mov_b32 s40, s4
  s_and_b32 s41, s5, 0xffff
  s_mov_b32 s42, 1835008
  s_mov_b32 s43, 0x20000
  s_lshr_b32 s75, s2, 2
  s_lshl_b32 s75, s75, 5
  s_lshl_b32 s79, s65, 4
  s_add_u32 s75, s75, s79
  s_and_b32 s79, s2, 3
  s_lshl_b32 s79, s79, 2
  s_add_u32 s75, s75, s79
  s_lshl_b32 s79, s66, 1
  s_add_u32 s75, s75, s79
  s_mul_i32 s81, s75, 896
  v_and_b32 v7, 31, v0
  v_lshrrev_b32 v8, 5, v0
  v_mul_u32_u24 v8, 896, v8
  v_lshlrev_b32 v9, 5, v7
  v_add_u32 v8, v8, v9
  v_mov_b32 v9, 0x7ffffff0
  v_cmp_gt_u32 vcc, 28, v7
  s_nop 1
  v_cndmask_b32 v8, v9, v8, vcc
  buffer_load_dwordx4 v[16:19], v8, s[40:43], s81 offen
  buffer_load_dwordx4 v[20:23], v8, s[40:43], s81 offen offset:16
  s_getpc_b64 s[98:99]
L_pc0:
  s_sub_u32 s98, s98, L_pc0-parallel_sum__ssm_conv_s5__mixer_token_mlp__prompt_kernel
  s_subb_u32 s99, s99, 0
  s_and_b32 s79, s23, 1
  s_lshl_b32 s79, s79, 2
  s_add_u32 s79, s79, s64
  s_lshl_b32 s79, s79, 13
  v_lshlrev_b32 v9, 7, v0
  v_add_u32 v9, s79, v9
  v_min_u32 v9, L_code_end-parallel_sum__ssm_conv_s5__mixer_token_mlp__prompt_kernel-16, v9
  global_load_dword v12, v9, s[98:99]
  s_mov_b32 s44, s36
  s_and_b32 s45, s37, 0xffff
  s_mov_b32 s46, 268435456
  s_mov_b32 s47, 0x20000
  s_mul_i32 s84, s64, 26624
  s_add_u32 s84, s84, 57344
  s_sub_u32 s85, s23, 28
  s_lshl_b32 s85, s85, 3
  s_add_u32 s85, s85, s22
  s_mov_b32 s86, s23
  s_mov_b32 s95, s22
  s_mov_b32 s48, s10
  s_and_b32 s49, s11, 0xffff
  s_mov_b32 s50, 401408
  s_mov_b32 s51, 0x20000
  s_mov_b32 s52, s12
  s_and_b32 s53, s13, 0xffff
  s_mov_b32 s54, 401408
  s_mov_b32 s55, 0x20000
  s_mov_b32 s56, s24
  s_and_b32 s57, s25, 0xffff
  s_mov_b32 s58, 7340032
  s_mov_b32 s59, 0x20000
  v_lshrrev_b32 v7, 3, v0
  v_and_b32 v8, 7, v0
  v_min_u32 v8, 6, v8
  v_mul_u32_u24 v7, 896, v7
  v_lshlrev_b32 v8, 7, v8
  v_add_u32 v7, v7, v8
  s_lshl_b32 s82, s86, 2
  s_add_u32 s82, s82, s64
  s_lshl_b32 s79, s95, 8
  s_lshl_b32 s80, s82, 1
  s_add_u32 s79, s79, s80
  s_mul_i32 s79, s79, 896
  s_mov_b32 exec_lo, 0xffff
  s_mov_b32 exec_hi, 0
  buffer_load_dword v12, v7, s[40:43], s79 offen
  s_and_b32 s79, s82, 63
  s_mul_i32 s79, s79, 6272
  s_cmp_lt_u32 s82, 64
  s_cselect_b32 s60, s10, s12
  s_cselect_b32 s61, s11, s13
  s_mov_b32 s62, 401408
  s_mov_b32 s63, 0x20000
  s_mov_b32 exec_lo, -1
  s_mov_b32 exec_hi, 0x00ffffff
  buffer_load_dword v12, v7, s[60:63], s79 offen
  s_mov_b64 exec, -1
  s_cmp_eq_u32 s74, 1
  s_cbranch_scc1 L_cont_1
  s_waitcnt vmcnt(3)
  v_dot2_f32_bf16 v24, v16, s73, 0
  v_dot2_f32_bf16 v25, v16, v16, 0
  v_dot2_f32_bf16 v26, v17, s73, 0
  v_dot2_f32_bf16 v27, v17, v17, 0
  v_dot2_f32_bf16 v24, v18, s73, v24
  v_dot2_f32_bf16 v25, v18, v18, v25
  v_dot2_f32_bf16 v26, v19, s73, v26
  v_dot2_f32_bf16 v27, v19, v19, v27
  v_dot2_f32_bf16 v24, v20, s73, v24
  v_dot2_f32_bf16 v25, v20, v20, v25
  v_dot2_f32_bf16 v26, v21, s73, v26
  v_dot2_f32_bf16 v27, v21, v21, v27
  v_dot2_f32_bf16 v24, v22, s73, v24
  v_dot2_f32_bf16 v25, v22, v22, v25
  v_dot2_f32_bf16 v26, v23, s73, v26
  v_dot2_f32_bf16 v27, v23, v23, v27
  s_nop 1
  v_add_f32 v24, v24, v26
  v_add_f32 v25, v25, v27
  s_nop 0
  v_add_f32_dpp v24, v24, v24 row_ror:8 row_mask:0xf bank_mask:0xf
  v_add_f32_dpp v25, v25, v25 row_ror:8 row_mask:0xf bank_mask:0xf
  s_nop 0
  v_add_f32_dpp v24, v24, v24 row_ror:4 row_mask:0xf bank_mask:0xf
  v_add_f32_dpp v25, v25, v25 row_ror:4 row_mask:0xf bank_mask:0xf
  s_nop 0
  v_add_f32_dpp v24, v24, v24 row_ror:2 row_mask:0xf bank_mask:0xf
  v_add_f32_dpp v25, v25, v25 row_ror:2 row_mask:0xf bank_mask:0xf
  s_nop 0
  v_add_f32_dpp v24, v24, v24 row_ror:1 row_mask:0xf bank_mask:0xf
  v_add_f32_dpp v25, v25, v25 row_ror:1 row_mask:0xf bank_mask:0xf
  v_mov_b32 v26, v24
  v_mov_b32 v27, v25
  s_nop 0
  v_permlane16_swap_b32 v24, v26
  v_permlane16_swap_b32 v25, v27
  v_add_f32 v24, v24, v26
  v_add_f32 v25, v25, v27
  v_mul_f32 v24, 0x3b124925, v24
  v_mul_f32 v25, 0x3b124925, v25
  v_fma_f32 v25, -v24, v24, v25
  v_max_f32 v25, 0, v25
  v_cvt_pk_bf16_f32 v24, v24, v24
  v_cvt_pk_bf16_f32 v25, v25, v25
  v_lshlrev_b32 v24, 16, v24
  v_lshlrev_b32 v25, 16, v25
  v_add_f32 v25, 0x3727c5ac, v25
  v_cvt_pk_bf16_f32 v25, v25, v25
  v_lshlrev_b32 v25, 16, v25
  v_sqrt_f32 v25, v25
  s_nop 0
  v_cvt_pk_bf16_f32 v25, v25, v25
  v_lshlrev_b32 v25, 16, v25
  v_rcp_f32 v28, v25
  s_nop 0
  v_mul_f32 v30, v24, v28
  v_sub_f32 v30, 0, v30
  v_and_b32 v7, 31, v0
  v_cmp_gt_u32 vcc, 28, v7
  s_nop 1
  v_cndmask_b32 v28, 0, v28, vcc
  v_cndmask_b32 v30, 0, v30, vcc
  v_lshlrev_b32 v32, 16, v16
  v_and_b32 v33, s72, v16
  v_lshlrev_b32 v34, 16, v17
  v_and_b32 v35, s72, v17
  v_lshlrev_b32 v36, 16, v18
  v_and_b32 v37, s72, v18
  v_lshlrev_b32 v38, 16, v19
  v_and_b32 v39, s72, v19
  v_pk_fma_f32 v[32:33], v[32:33], v[28:29], v[30:31] op_sel_hi:[1,0,0]
  v_pk_fma_f32 v[34:35], v[34:35], v[28:29], v[30:31] op_sel_hi:[1,0,0]
  v_pk_fma_f32 v[36:37], v[36:37], v[28:29], v[30:31] op_sel_hi:[1,0,0]
  v_pk_fma_f32 v[38:39], v[38:39], v[28:29], v[30:31] op_sel_hi:[1,0,0]
  v_cvt_pk_bf16_f32 v16, v32, v33
  v_cvt_pk_bf16_f32 v17, v34, v35
  v_cvt_pk_bf16_f32 v18, v36, v37
  v_cvt_pk_bf16_f32 v19, v38, v39
  v_lshlrev_b32 v32, 16, v20
  v_and_b32 v33, s72, v20
  v_lshlrev_b32 v34, 16, v21
  v_and_b32 v35, s72, v21
  v_lshlrev_b32 v36, 16, v22
  v_and_b32 v37, s72, v22
  v_lshlrev_b32 v38, 16, v23
  v_and_b32 v39, s72, v23
  v_pk_fma_f32 v[32:33], v[32:33], v[28:29], v[30:31] op_sel_hi:[1,0,0]
  v_pk_fma_f32 v[34:35], v[34:35], v[28:29], v[30:31] op_sel_hi:[1,0,0]
  v_pk_fma_f32 v[36:37], v[36:37], v[28:29], v[30:31] op_sel_hi:[1,0,0]
  v_pk_fma_f32 v[38:39], v[38:39], v[28:29], v[30:31] op_sel_hi:[1,0,0]
  v_cvt_pk_bf16_f32 v20, v32, v33
  v_cvt_pk_bf16_f32 v21, v34, v35
  v_cvt_pk_bf16_f32 v22, v36, v37
  v_cvt_pk_bf16_f32 v23, v38, v39
  v_dot2_f32_bf16 v24, v16, s73, 0
  v_dot2_f32_bf16 v25, v16, v16, 0
  v_dot2_f32_bf16 v26, v17, s73, 0
  v_dot2_f32_bf16 v27, v17, v17, 0
  v_dot2_f32_bf16 v24, v18, s73, v24
  v_dot2_f32_bf16 v25, v18, v18, v25
  v_dot2_f32_bf16 v26, v19, s73, v26
  v_dot2_f32_bf16 v27, v19, v19, v27
  v_dot2_f32_bf16 v24, v20, s73, v24
  v_dot2_f32_bf16 v25, v20, v20, v25
  v_dot2_f32_bf16 v26, v21, s73, v26
  v_dot2_f32_bf16 v27, v21, v21, v27
  v_dot2_f32_bf16 v24, v22, s73, v24
  v_dot2_f32_bf16 v25, v22, v22, v25
  v_dot2_f32_bf16 v26, v23, s73, v26
  v_dot2_f32_bf16 v27, v23, v23, v27
  s_nop 1
  v_add_f32 v24, v24, v26
  v_add_f32 v25, v25, v27
  s_nop 0
  v_add_f32_dpp v24, v24, v24 row_ror:8 row_mask:0xf bank_mask:0xf
  v_add_f32_dpp v25, v25, v25 row_ror:8 row_mask:0xf bank_mask:0xf
  s_nop 0
  v_add_f32_dpp v24, v24, v24 row_ror:4 row_mask:0xf bank_mask:0xf
  v_add_f32_dpp v25, v25, v25 row_ror:4 row_mask:0xf bank_mask:0xf
  s_nop 0
  v_add_f32_dpp v24, v24, v24 row_ror:2 row_mask:0xf bank_mask:0xf
  v_add_f32_dpp v25, v25, v25 row_ror:2 row_mask:0xf bank_mask:0xf
  s_nop 0
  v_add_f32_dpp v24, v24, v24 row_ror:1 row_mask:0xf bank_mask:0xf
  v_add_f32_dpp v25, v25, v25 row_ror:1 row_mask:0xf bank_mask:0xf
  v_mov_b32 v26, v24
  v_mov_b32 v27, v25
  s_nop 0
  v_permlane16_swap_b32 v24, v26
  v_permlane16_swap_b32 v25, v27
  v_add_f32 v24, v24, v26
  v_add_f32 v25, v25, v27
  v_mul_f32 v24, 0x3b124925, v24
  v_mul_f32 v25, 0x3b124925, v25
  v_fma_f32 v25, -v24, v24, v25
  v_max_f32 v25, 0, v25
  v_cvt_pk_bf16_f32 v24, v24, v24
  v_cvt_pk_bf16_f32 v25, v25, v25
  v_lshlrev_b32 v24, 16, v24
  v_lshlrev_b32 v25, 16, v25
  v_add_f32 v25, 0x3727c5ac, v25
  v_cvt_pk_bf16_f32 v25, v25, v25
  v_lshlrev_b32 v25, 16, v25
  v_sqrt_f32 v25, v25
  s_nop 0
  v_cvt_pk_bf16_f32 v25, v25, v25
  v_lshlrev_b32 v25, 16, v25
  v_rcp_f32 v28, v25
  s_nop 0
  v_mul_f32 v30, v24, v28
  v_sub_f32 v30, 0, v30
  v_lshlrev_b32 v32, 16, v16
  v_and_b32 v33, s72, v16
  v_lshlrev_b32 v34, 16, v17
  v_and_b32 v35, s72, v17
  v_lshlrev_b32 v36, 16, v18
  v_and_b32 v37, s72, v18
  v_lshlrev_b32 v38, 16, v19
  v_and_b32 v39, s72, v19
  v_pk_fma_f32 v[32:33], v[32:33], v[28:29], v[30:31] op_sel_hi:[1,0,0]
  v_pk_fma_f32 v[34:35], v[34:35], v[28:29], v[30:31] op_sel_hi:[1,0,0]
  v_pk_fma_f32 v[36:37], v[36:37], v[28:29], v[30:31] op_sel_hi:[1,0,0]
  v_pk_fma_f32 v[38:39], v[38:39], v[28:29], v[30:31] op_sel_hi:[1,0,0]
  v_cvt_pk_bf16_f32 v16, v32, v33
  v_cvt_pk_bf16_f32 v17, v34, v35
  v_cvt_pk_bf16_f32 v18, v36, v37
  v_cvt_pk_bf16_f32 v19, v38, v39
  v_lshlrev_b32 v32, 16, v20
  v_and_b32 v33, s72, v20
  v_lshlrev_b32 v34, 16, v21
  v_and_b32 v35, s72, v21
  v_lshlrev_b32 v36, 16, v22
  v_and_b32 v37, s72, v22
  v_lshlrev_b32 v38, 16, v23
  v_and_b32 v39, s72, v23
  v_pk_fma_f32 v[32:33], v[32:33], v[28:29], v[30:31] op_sel_hi:[1,0,0]
  v_pk_fma_f32 v[34:35], v[34:35], v[28:29], v[30:31] op_sel_hi:[1,0,0]
  v_pk_fma_f32 v[36:37], v[36:37], v[28:29], v[30:31] op_sel_hi:[1,0,0]
  v_pk_fma_f32 v[38:39], v[38:39], v[28:29], v[30:31] op_sel_hi:[1,0,0]
  v_cvt_pk_bf16_f32 v20, v32, v33
  v_cvt_pk_bf16_f32 v21, v34, v35
  v_cvt_pk_bf16_f32 v22, v36, v37
  v_cvt_pk_bf16_f32 v23, v38, v39
  v_lshrrev_b32 v8, 5, v0
  s_lshl_b32 s79, s64, 1
  v_add_u32 v8, s79, v8
  v_mul_u32_u24 v8, 960, v8
  v_lshlrev_b32 v9, 5, v7
  v_add_u32 v8, v8, v9
  v_add_u32 v8, 49664, v8
  s_mov_b32 exec_lo, 0x0fffffff
  s_mov_b32 exec_hi, 0x0fffffff
  ds_write_b128 v8, v[16:19] offset:0
  ds_write_b128 v8, v[20:23] offset:16
  s_mov_b64 exec, -1
  s_waitcnt lgkmcnt(0)
  s_barrier
  v_and_b32 v7, 15, v0
  v_lshrrev_b32 v8, 2, v7
  v_mul_u32_u24 v8, 960, v8
  v_lshrrev_b32 v9, 4, v0
  v_lshlrev_b32 v10, 5, v9
  v_add_u32 v8, v8, v10
  v_and_b32 v10, 3, v0
  v_lshlrev_b32 v10, 3, v10
  v_add_u32 v8, v8, v10
  s_lshl_b32 s79, s64, 7
  s_add_u32 s79, s79, 49664
  v_add_u32 v8, s79, v8
  v_lshlrev_b32 v9, 10, v9
  v_lshlrev_b32 v7, 4, v7
  v_add_u32 v9, v9, v7
  s_lshr_b32 s79, s2, 2
  s_lshl_b32 s79, s79, 12
  s_and_b32 s80, s2, 3
  s_lshl_b32 s80, s80, 8
  s_add_u32 s79, s79, s80
  s_lshl_b32 s80, s64, 18
  s_add_u32 s79, s79, s80
  ds_read_b64_tr_b16 v[16:17], v8 offset:0
  ds_read_b64_tr_b16 v[18:19], v8 offset:3840
  s_cmp_eq_u32 s64, 3
  s_cbranch_scc1 L_ln8skip_2
  ds_read_b64_tr_b16 v[20:21], v8 offset:512
  ds_read_b64_tr_b16 v[22:23], v8 offset:4352
  s_add_u32 s80, s79, 1048576
  s_waitcnt lgkmcnt(0)
  buffer_store_dwordx4 v[20:23], v9, s[44:47], s80 offen sc1
L_ln8skip_2:
  s_waitcnt lgkmcnt(0)
  buffer_store_dwordx4 v[16:19], v9, s[44:47], s79 offen sc1
  s_barrier
  s_waitcnt vmcnt(0)
  s_barrier
  s_cmp_lg_u32 s64, 0
  s_cbranch_scc1 L_arr_3
  s_and_b32 s3, s2, 3
  s_lshl_b32 s3, s3, 6
  v_mov_b32 v8, s3
  v_mov_b32 v9, 1
  s_mov_b32 exec_lo, 1
  s_mov_b32 exec_hi, 0
  global_atomic_add v8, v9, s[34:35] sc1
  s_mov_b64 exec, -1
L_arr_3:
  v_lshrrev_b32 v7, 3, v0
  v_and_b32 v8, 7, v0
  v_min_u32 v8, 6, v8
  v_mul_u32_u24 v7, 3584, v7
  v_lshlrev_b32 v8, 7, v8
  v_add_u32 v7, v7, v8
  s_lshl_b32 s79, s64, 9
  s_and_b32 s81, s95, 1
  s_sub_u32 s80, s86, 28
  s_lshl_b32 s80, s80, 3
  s_add_u32 s79, s79, s80
  s_add_u32 s79, s79, 224
  s_lshl_b32 s80, s81, 5
  s_add_u32 s79, s79, s80
  s_mul_i32 s79, s79, 3584
  s_lshl_b32 s80, s87, 7
  s_add_u32 s79, s79, s80
  buffer_load_dword v12, v7, s[56:59], s79 offen
  s_add_u32 s79, s79, 229376
  buffer_load_dword v12, v7, s[56:59], s79 offen
  s_add_u32 s79, s79, 229376
  buffer_load_dword v12, v7, s[56:59], s79 offen
  s_add_u32 s79, s79, 229376
  buffer_load_dword v12, v7, s[56:59], s79 offen
  s_add_u32 s79, s79, 229376
  buffer_load_dword v12, v7, s[56:59], s79 offen
  s_mov_b32 s60, s28
  s_and_b32 s61, s29, 0xffff
  s_mov_b32 s62, 7340032
  s_mov_b32 s63, 0x20000
  v_lshrrev_b32 v7, 2, v0
  v_and_b32 v8, 3, v0
  v_mul_u32_u24 v7, 4096, v7
  v_lshlrev_b32 v8, 7, v8
  v_add_u32 v7, v7, v8
  s_mul_i32 s79, s64, 448
  s_sub_u32 s80, s86, 28
  s_lshl_b32 s80, s80, 4
  s_add_u32 s79, s79, s80
  s_mul_i32 s79, s79, 4096
  s_lshl_b32 s80, s95, 9
  s_add_u32 s79, s79, s80
  buffer_load_dword v12, v7, s[60:63], s79 offen
  s_add_u32 s79, s79, 262144
  buffer_load_dword v12, v7, s[60:63], s79 offen
  s_add_u32 s79, s79, 262144
  buffer_load_dword v12, v7, s[60:63], s79 offen
  s_add_u32 s79, s79, 262144
  buffer_load_dword v12, v7, s[60:63], s79 offen
  s_add_u32 s79, s79, 262144
  buffer_load_dword v12, v7, s[60:63], s79 offen
  s_add_u32 s79, s79, 262144
  buffer_load_dword v12, v7, s[60:63], s79 offen
  s_add_u32 s79, s79, 262144
  buffer_load_dword v12, v7, s[60:63], s79 offen
  s_waitcnt vmcnt(0)
  s_endpgm
L_cont_1:
  v_xor_b32 v224, 0, v1
  v_xor_b32 v225, 48, v1
  v_xor_b32 v226, 32, v1
  v_xor_b32 v227, 16, v1
  v_xor_b32 v228, 0, v1
  v_xor_b32 v229, 16, v1
  v_xor_b32 v230, 32, v1
  v_xor_b32 v231, 48, v1
  v_xor_b32 v232, 64, v1
  v_xor_b32 v233, 80, v1
  v_xor_b32 v234, 96, v1
  v_xor_b32 v235, 112, v1
  s_lshl_b32 s79, s68, 6
  s_lshl_b32 s80, s64, 4
  s_add_u32 s88, s79, s80
  s_mul_i32 s89, s88, 896
  s_lshl_b32 s79, s67, 6
  s_lshl_b32 s80, s64, 2
  s_add_u32 s79, s79, s80
  s_mul_i32 s92, s79, 896
  s_mul_i32 s93, s64, 3584
  v_and_b32 v7, 15, v0
  v_mul_u32_u24 v236, 896, v7
  v_lshrrev_b32 v9, 4, v0
  v_lshlrev_b32 v9, 4, v9
  v_add_u32 v236, v236, v9
  v_add_u32 v237, s88, v7
  v_lshlrev_b32 v237, 1, v237
  v_lshrrev_b32 v7, 3, v0
  v_and_b32 v8, 7, v0
  v_and_b32 v9, 6, v7
  v_xor_b32 v8, v8, v9
  v_lshlrev_b32 v8, 4, v8
  v_mul_u32_u24 v7, 3584, v7
  v_add_u32 v6, v7, v8
  v_add_u32 v13, 27648, v6
  v_lshrrev_b32 v7, 2, v0
  v_and_b32 v8, 6, v7
  v_bfe_u32 v9, v0, 1, 1
  v_xor_b32 v8, v8, v9
  v_lshlrev_b32 v8, 4, v8
  v_lshlrev_b32 v7, 7, v7
  v_add_u32 v7, v7, v8
  v_and_b32 v9, 1, v0
  v_lshlrev_b32 v9, 3, v9
  v_add_u32 v7, v7, v9
  s_lshl_b32 s79, s65, 6
  v_xor_b32 v7, s79, v7
  v_add_u32 v2, s84, v7
  v_xor_b32 v3, 32, v2
  v_xor_b32 v4, 64, v2
  v_xor_b32 v5, 96, v2
  s_mul_i32 s96, s64, 1835008
  s_lshl_b32 s79, s70, 7
  s_add_u32 s96, s96, s79
  s_mov_b32 s78, s96
  global_load_ushort v52, v237, s[6:7]
  global_load_ushort v53, v237, s[8:9]
  global_load_ushort v54, v237, s[18:19]
  s_waitcnt vmcnt(6)
  v_dot2_f32_bf16 v24, v16, s73, 0
  v_dot2_f32_bf16 v25, v16, v16, 0
  v_dot2_f32_bf16 v26, v17, s73, 0
  v_dot2_f32_bf16 v27, v17, v17, 0
  v_dot2_f32_bf16 v24, v18, s73, v24
  v_dot2_f32_bf16 v25, v18, v18, v25
  v_dot2_f32_bf16 v26, v19, s73, v26
  v_dot2_f32_bf16 v27, v19, v19, v27
  v_dot2_f32_bf16 v24, v20, s73, v24
  v_dot2_f32_bf16 v25, v20, v20, v25
  v_dot2_f32_bf16 v26, v21, s73, v26
  v_dot2_f32_bf16 v27, v21, v21, v27
  v_dot2_f32_bf16 v24, v22, s73, v24
  v_dot2_f32_bf16 v25, v22, v22, v25
  v_dot2_f32_bf16 v26, v23, s73, v26
  v_dot2_f32_bf16 v27, v23, v23, v27
  s_nop 1
  v_add_f32 v24, v24, v26
  v_add_f32 v25, v25, v27
  s_nop 0
  v_add_f32_dpp v24, v24, v24 row_ror:8 row_mask:0xf bank_mask:0xf
  v_add_f32_dpp v25, v25, v25 row_ror:8 row_mask:0xf bank_mask:0xf
  s_nop 0
  v_add_f32_dpp v24, v24, v24 row_ror:4 row_mask:0xf bank_mask:0xf
  v_add_f32_dpp v25, v25, v25 row_ror:4 row_mask:0xf bank_mask:0xf
  s_nop 0
  v_add_f32_dpp v24, v24, v24 row_ror:2 row_mask:0xf bank_mask:0xf
  v_add_f32_dpp v25, v25, v25 row_ror:2 row_mask:0xf bank_mask:0xf
  s_nop 0
  v_add_f32_dpp v24, v24, v24 row_ror:1 row_mask:0xf bank_mask:0xf
  v_add_f32_dpp v25, v25, v25 row_ror:1 row_mask:0xf bank_mask:0xf
  v_mov_b32 v26, v24
  v_mov_b32 v27, v25
  s_nop 0
  v_permlane16_swap_b32 v24, v26
  v_permlane16_swap_b32 v25, v27
  v_add_f32 v24, v24, v26
  v_add_f32 v25, v25, v27
  v_mul_f32 v24, 0x3b124925, v24
  v_mul_f32 v25, 0x3b124925, v25
  v_fma_f32 v25, -v24, v24, v25
  v_max_f32 v25, 0, v25
  v_cvt_pk_bf16_f32 v24, v24, v24
  v_cvt_pk_bf16_f32 v25, v25, v25
  v_lshlrev_b32 v24, 16, v24
  v_lshlrev_b32 v25, 16, v25
  v_add_f32 v25, 0x3727c5ac, v25
  v_cvt_pk_bf16_f32 v25, v25, v25
  v_lshlrev_b32 v25, 16, v25
  v_sqrt_f32 v25, v25
  s_nop 0
  v_cvt_pk_bf16_f32 v25, v25, v25
  v_lshlrev_b32 v25, 16, v25
  v_rcp_f32 v28, v25
  s_nop 0
  v_mul_f32 v30, v24, v28
  v_sub_f32 v30, 0, v30
  v_and_b32 v7, 31, v0
  v_cmp_gt_u32 vcc, 28, v7
  s_nop 1
  v_cndmask_b32 v28, 0, v28, vcc
  v_cndmask_b32 v30, 0, v30, vcc
  v_lshlrev_b32 v32, 16, v16
  v_and_b32 v33, s72, v16
  v_lshlrev_b32 v34, 16, v17
  v_and_b32 v35, s72, v17
  v_lshlrev_b32 v36, 16, v18
  v_and_b32 v37, s72, v18
  v_lshlrev_b32 v38, 16, v19
  v_and_b32 v39, s72, v19
  v_pk_fma_f32 v[32:33], v[32:33], v[28:29], v[30:31] op_sel_hi:[1,0,0]
  v_pk_fma_f32 v[34:35], v[34:35], v[28:29], v[30:31] op_sel_hi:[1,0,0]
  v_pk_fma_f32 v[36:37], v[36:37], v[28:29], v[30:31] op_sel_hi:[1,0,0]
  v_pk_fma_f32 v[38:39], v[38:39], v[28:29], v[30:31] op_sel_hi:[1,0,0]
  v_cvt_pk_bf16_f32 v16, v32, v33
  v_cvt_pk_bf16_f32 v17, v34, v35
  v_cvt_pk_bf16_f32 v18, v36, v37
  v_cvt_pk_bf16_f32 v19, v38, v39
  v_lshlrev_b32 v32, 16, v20
  v_and_b32 v33, s72, v20
  v_lshlrev_b32 v34, 16, v21
  v_and_b32 v35, s72, v21
  v_lshlrev_b32 v36, 16, v22
  v_and_b32 v37, s72, v22
  v_lshlrev_b32 v38, 16, v23
  v_and_b32 v39, s72, v23
  v_pk_fma_f32 v[32:33], v[32:33], v[28:29], v[30:31] op_sel_hi:[1,0,0]
  v_pk_fma_f32 v[34:35], v[34:35], v[28:29], v[30:31] op_sel_hi:[1,0,0]
  v_pk_fma_f32 v[36:37], v[36:37], v[28:29], v[30:31] op_sel_hi:[1,0,0]
  v_pk_fma_f32 v[38:39], v[38:39], v[28:29], v[30:31] op_sel_hi:[1,0,0]
  v_cvt_pk_bf16_f32 v20, v32, v33
  v_cvt_pk_bf16_f32 v21, v34, v35
  v_cvt_pk_bf16_f32 v22, v36, v37
  v_cvt_pk_bf16_f32 v23, v38, v39
  v_dot2_f32_bf16 v24, v16, s73, 0
  v_dot2_f32_bf16 v25, v16, v16, 0
  v_dot2_f32_bf16 v26, v17, s73, 0
  v_dot2_f32_bf16 v27, v17, v17, 0
  v_dot2_f32_bf16 v24, v18, s73, v24
  v_dot2_f32_bf16 v25, v18, v18, v25
  v_dot2_f32_bf16 v26, v19, s73, v26
  v_dot2_f32_bf16 v27, v19, v19, v27
  v_dot2_f32_bf16 v24, v20, s73, v24
  v_dot2_f32_bf16 v25, v20, v20, v25
  v_dot2_f32_bf16 v26, v21, s73, v26
  v_dot2_f32_bf16 v27, v21, v21, v27
  v_dot2_f32_bf16 v24, v22, s73, v24
  v_dot2_f32_bf16 v25, v22, v22, v25
  v_dot2_f32_bf16 v26, v23, s73, v26
  v_dot2_f32_bf16 v27, v23, v23, v27
  s_nop 1
  v_add_f32 v24, v24, v26
  v_add_f32 v25, v25, v27
  s_nop 0
  v_add_f32_dpp v24, v24, v24 row_ror:8 row_mask:0xf bank_mask:0xf
  v_add_f32_dpp v25, v25, v25 row_ror:8 row_mask:0xf bank_mask:0xf
  s_nop 0
  v_add_f32_dpp v24, v24, v24 row_ror:4 row_mask:0xf bank_mask:0xf
  v_add_f32_dpp v25, v25, v25 row_ror:4 row_mask:0xf bank_mask:0xf
  s_nop 0
  v_add_f32_dpp v24, v24, v24 row_ror:2 row_mask:0xf bank_mask:0xf
  v_add_f32_dpp v25, v25, v25 row_ror:2 row_mask:0xf bank_mask:0xf
  s_nop 0
  v_add_f32_dpp v24, v24, v24 row_ror:1 row_mask:0xf bank_mask:0xf
  v_add_f32_dpp v25, v25, v25 row_ror:1 row_mask:0xf bank_mask:0xf
  v_mov_b32 v26, v24
  v_mov_b32 v27, v25
  s_nop 0
  v_permlane16_swap_b32 v24, v26
  v_permlane16_swap_b32 v25, v27
  v_add_f32 v24, v24, v26
  v_add_f32 v25, v25, v27
  v_mul_f32 v24, 0x3b124925, v24
  v_mul_f32 v25, 0x3b124925, v25
  v_fma_f32 v25, -v24, v24, v25
  v_max_f32 v25, 0, v25
  v_cvt_pk_bf16_f32 v24, v24, v24
  v_cvt_pk_bf16_f32 v25, v25, v25
  v_lshlrev_b32 v24, 16, v24
  v_lshlrev_b32 v25, 16, v25
  v_add_f32 v25, 0x3727c5ac, v25
  v_cvt_pk_bf16_f32 v25, v25, v25
  v_lshlrev_b32 v25, 16, v25
  v_sqrt_f32 v25, v25
  s_nop 0
  v_cvt_pk_bf16_f32 v25, v25, v25
  v_lshlrev_b32 v25, 16, v25
  v_rcp_f32 v28, v25
  s_nop 0
  v_mul_f32 v30, v24, v28
  v_sub_f32 v30, 0, v30
  v_lshlrev_b32 v32, 16, v16
  v_and_b32 v33, s72, v16
  v_lshlrev_b32 v34, 16, v17
  v_and_b32 v35, s72, v17
  v_lshlrev_b32 v36, 16, v18
  v_and_b32 v37, s72, v18
  v_lshlrev_b32 v38, 16, v19
  v_and_b32 v39, s72, v19
  v_pk_fma_f32 v[32:33], v[32:33], v[28:29], v[30:31] op_sel_hi:[1,0,0]
  v_pk_fma_f32 v[34:35], v[34:35], v[28:29], v[30:31] op_sel_hi:[1,0,0]
  v_pk_fma_f32 v[36:37], v[36:37], v[28:29], v[30:31] op_sel_hi:[1,0,0]
  v_pk_fma_f32 v[38:39], v[38:39], v[28:29], v[30:31] op_sel_hi:[1,0,0]
  v_cvt_pk_bf16_f32 v16, v32, v33
  v_cvt_pk_bf16_f32 v17, v34, v35
  v_cvt_pk_bf16_f32 v18, v36, v37
  v_cvt_pk_bf16_f32 v19, v38, v39
  v_lshlrev_b32 v32, 16, v20
  v_and_b32 v33, s72, v20
  v_lshlrev_b32 v34, 16, v21
  v_and_b32 v35, s72, v21
  v_lshlrev_b32 v36, 16, v22
  v_and_b32 v37, s72, v22
  v_lshlrev_b32 v38, 16, v23
  v_and_b32 v39, s72, v23
  v_pk_fma_f32 v[32:33], v[32:33], v[28:29], v[30:31] op_sel_hi:[1,0,0]
  v_pk_fma_f32 v[34:35], v[34:35], v[28:29], v[30:31] op_sel_hi:[1,0,0]
  v_pk_fma_f32 v[36:37], v[36:37], v[28:29], v[30:31] op_sel_hi:[1,0,0]
  v_pk_fma_f32 v[38:39], v[38:39], v[28:29], v[30:31] op_sel_hi:[1,0,0]
  v_cvt_pk_bf16_f32 v20, v32, v33
  v_cvt_pk_bf16_f32 v21, v34, v35
  v_cvt_pk_bf16_f32 v22, v36, v37
  v_cvt_pk_bf16_f32 v23, v38, v39
  v_lshrrev_b32 v8, 5, v0
  s_lshl_b32 s79, s64, 1
  v_add_u32 v8, s79, v8
  v_mul_u32_u24 v8, 960, v8
  v_lshlrev_b32 v9, 5, v7
  v_add_u32 v8, v8, v9
  v_add_u32 v8, 49664, v8
  s_mov_b32 exec_lo, 0x0fffffff
  s_mov_b32 exec_hi, 0x0fffffff
  ds_write_b128 v8, v[16:19] offset:0
  ds_write_b128 v8, v[20:23] offset:16
  s_mov_b64 exec, -1
  s_waitcnt lgkmcnt(0)
  s_barrier
  v_and_b32 v7, 15, v0
  v_lshrrev_b32 v8, 2, v7
  v_mul_u32_u24 v8, 960, v8
  v_lshrrev_b32 v9, 4, v0
  v_lshlrev_b32 v10, 5, v9
  v_add_u32 v8, v8, v10
  v_and_b32 v10, 3, v0
  v_lshlrev_b32 v10, 3, v10
  v_add_u32 v8, v8, v10
  s_lshl_b32 s79, s64, 7
  s_add_u32 s79, s79, 49664
  v_add_u32 v8, s79, v8
  v_lshlrev_b32 v9, 10, v9
  v_lshlrev_b32 v7, 4, v7
  v_add_u32 v9, v9, v7
  s_lshr_b32 s79, s2, 2
  s_lshl_b32 s79, s79, 12
  s_and_b32 s80, s2, 3
  s_lshl_b32 s80, s80, 8
  s_add_u32 s79, s79, s80
  s_lshl_b32 s80, s64, 18
  s_add_u32 s79, s79, s80
  ds_read_b64_tr_b16 v[16:17], v8 offset:0
  ds_read_b64_tr_b16 v[18:19], v8 offset:3840
  s_cmp_eq_u32 s64, 3
  s_cbranch_scc1 L_ln8skip_4
  ds_read_b64_tr_b16 v[20:21], v8 offset:512
  ds_read_b64_tr_b16 v[22:23], v8 offset:4352
  s_add_u32 s80, s79, 1048576
  s_waitcnt lgkmcnt(0)
  buffer_store_dwordx4 v[20:23], v9, s[44:47], s80 offen sc1
L_ln8skip_4:
  s_waitcnt lgkmcnt(0)
  buffer_store_dwordx4 v[16:19], v9, s[44:47], s79 offen sc1
  s_cmp_lg_u32 s64, 3
  s_cbranch_scc1 L_noclr_5
  v_mov_b32 v8, 0
  v_mov_b32 v10, -1
  v_mov_b32 v11, -1
  v_lshlrev_b32 v9, 3, v0
  s_lshl_b32 s79, s68, 5
  s_add_u32 s79, s79, s67
  s_lshl_b32 s79, s79, 9
  s_add_u32 s79, s79, 1851392
  buffer_store_dwordx2 v[10:11], v9, s[44:47], s79 offen sc1
  s_mul_i32 s79, s67, 7
  s_add_u32 s79, s79, s68
  s_lshl_b32 s79, s79, 6
  s_add_u32 s79, s79, 1966080
  v_mov_b32 v10, 0
  s_mov_b32 exec_lo, 1
  s_mov_b32 exec_hi, 0
  buffer_store_dword v10, v8, s[44:47], s79 offen sc1
  s_cmp_eq_u32 s71, 0
  s_cbranch_scc1 L_nog1clr_6
  s_mul_i32 s79, s69, 28
  s_add_u32 s79, s79, s70
  s_lshl_b32 s79, s79, 6
  s_add_u32 s79, s79, 1982464
  buffer_store_dword v10, v8, s[44:47], s79 offen sc1
L_nog1clr_6:
  s_cmp_lg_u32 s95, 0
  s_cbranch_scc1 L_nocclr_7
  s_lshl_b32 s79, s86, 6
  s_add_u32 s79, s79, 1998848
  buffer_store_dword v10, v8, s[44:47], s79 offen sc1
L_nocclr_7:
  s_mov_b64 exec, -1
L_noclr_5:
  s_barrier
  v_and_b32 v7, 15, v0
  v_lshrrev_b32 v8, 2, v7
  v_lshlrev_b32 v8, 4, v8
  v_and_b32 v9, 3, v7
  v_add_u32 v8, v8, v9
  v_mul_u32_u24 v8, 896, v8
  v_lshrrev_b32 v9, 4, v0
  v_lshrrev_b32 v7, 1, v7
  v_xor_b32 v9, v9, v7
  v_lshlrev_b32 v9, 4, v9
  v_add_u32 v14, v8, v9
  v_xor_b32 v15, 64, v14
  s_mov_b32 exec_hi, 0x00ffffff
  s_add_u32 m0, s93, 43008
  s_add_u32 s91, s92, 43008
  buffer_load_dwordx4 v234, s[40:43], s91 offen lds
  s_mov_b32 exec_hi, -1
  s_waitcnt vmcnt(2)
  v_lshlrev_b32 v52, 16, v52
  v_lshlrev_b32 v53, 16, v53
  v_lshlrev_b32 v54, 16, v54
  v_mul_f32 v54, 0x3fb8aa3b, v54
  v_exp_f32 v54, v54
  s_nop 0
  v_cvt_pk_bf16_f32 v54, v54, v54
  v_lshlrev_b32 v54, 16, v54
  v_mul_f32 v16, v54, v52
  v_mul_f32 v17, v54, v53
  v_mul_f32 v16, 0x3fb8aa3b, v16
  v_mul_f32 v17, 0.15915494, v17
  s_mov_b32 exec_hi, 0x00ffffff
  s_add_u32 m0, s93, 43904
  s_add_u32 s91, s92, 43904
  buffer_load_dwordx4 v234, s[40:43], s91 offen lds
  s_mov_b32 exec_hi, -1
  v_exp_f32 v16, v16
  v_fract_f32 v17, v17
  v_cos_f32 v18, v17
  v_sin_f32 v19, v17
  v_mul_f32 v40, v16, v18
  v_mul_f32 v41, v16, v19
  v_add_f32 v16, -1.0, v40
  v_mul_f32 v17, v52, v52
  v_fma_f32 v17, v53, v53, v17
  s_mov_b32 exec_hi, 0x00ffffff
  s_add_u32 m0, s93, 44800
  s_add_u32 s91, s92, 44800
  buffer_load_dwordx4 v235, s[40:43], s91 offen lds
  s_mov_b32 exec_hi, -1
  v_rcp_f32 v17, v17
  v_mul_f32 v18, v16, v52
  v_fma_f32 v18, v41, v53, v18
  v_mul_f32 v19, v16, v53
  v_fma_f32 v19, v41, v52, -v19
  v_add_f32 v17, v17, v17
  v_mul_f32 v42, v18, v17
  v_mul_f32 v43, v19, v17
  v_sub_f32 v43, 0, v43
  v_mul_f32 v30, v41, v41
  v_mul_f32 v17, v40, v41
  s_mov_b32 exec_hi, 0x00ffffff
  s_add_u32 m0, s93, 45696
  s_add_u32 s91, s92, 45696
  buffer_load_dwordx4 v235, s[40:43], s91 offen lds
  s_mov_b32 exec_hi, -1
  v_fma_f32 v16, v40, v40, -v30
  v_add_f32 v17, v17, v17
  v_mul_f32 v30, v17, v17
  v_mul_f32 v19, v16, v17
  v_fma_f32 v18, v16, v16, -v30
  v_add_f32 v19, v19, v19
  v_mul_f32 v30, v19, v19
  v_mul_f32 v17, v18, v19
  v_fma_f32 v16, v18, v18, -v30
  v_add_f32 v17, v17, v17
  v_mul_f32 v30, v17, v17
  v_mul_f32 v21, v16, v17
  s_mov_b32 exec_hi, 0x00ffffff
  s_add_u32 m0, s93, 0
  s_add_u32 s91, s92, 0
  buffer_load_dwordx4 v228, s[40:43], s91 offen lds
  s_mov_b32 exec_hi, -1
  v_fma_f32 v20, v16, v16, -v30
  v_add_f32 v21, v21, v21
  v_mul_f32 v30, v21, v21
  v_mul_f32 v23, v20, v21
  v_fma_f32 v22, v20, v20, -v30
  v_add_f32 v23, v23, v23
  v_mul_f32 v30, v23, v21
  v_mul_f32 v31, v23, v20
  v_fma_f32 v30, v22, v20, -v30
  v_fma_f32 v25, v22, v21, v31
  v_mov_b32 v24, v30
  v_mul_f32 v30, v23, v23
  s_mov_b32 exec_hi, 0x00ffffff
  s_add_u32 m0, s93, 896
  s_add_u32 s91, s92, 896
  buffer_load_dwordx4 v228, s[40:43], s91 offen lds
  s_mov_b32 exec_hi, -1
  v_mul_f32 v49, v22, v23
  v_fma_f32 v48, v22, v22, -v30
  v_add_f32 v49, v49, v49
  v_mul_f32 v30, v49, v49
  v_mul_f32 v17, v48, v49
  v_fma_f32 v16, v48, v48, -v30
  v_add_f32 v17, v17, v17
  v_mul_f32 v30, v17, v17
  v_mul_f32 v19, v16, v17
  v_fma_f32 v18, v16, v16, -v30
  v_add_f32 v19, v19, v19
  v_mul_f32 v30, v19, v19
  s_mov_b32 exec_hi, 0x00ffffff
  s_add_u32 m0, s93, 1792
  s_add_u32 s91, s92, 1792
  buffer_load_dwordx4 v229, s[40:43], s91 offen lds
  s_mov_b32 exec_hi, -1
  v_mul_f32 v51, v18, v19
  v_fma_f32 v50, v18, v18, -v30
  v_add_f32 v51, v51, v51
  v_mov_b32 v46, 1.0
  v_mov_b32 v47, 0
  s_mov_b32 exec_lo, 0xffff0000
  s_mov_b32 exec_hi, -1
  v_mov_b32 v46, v20
  v_mov_b32 v47, v21
  s_mov_b32 exec_lo, 0
  s_mov_b32 exec_hi, -1
  v_mov_b32 v46, v22
  v_mov_b32 v47, v23
  s_mov_b32 exec_lo, 0
  s_mov_b32 exec_hi, 0xffff0000
  v_mov_b32 v46, v24
  v_mov_b32 v47, v25
  s_mov_b64 exec, -1
  v_mov_b32 v52, v20
  s_mov_b32 exec_hi, 0x00ffffff
  s_add_u32 m0, s93, 2688
  s_add_u32 s91, s92, 2688
  buffer_load_dwordx4 v229, s[40:43], s91 offen lds
  s_mov_b32 exec_hi, -1
  v_mov_b32 v53, v21
  s_waitcnt vmcnt(8)
  s_barrier
  s_cmp_lg_u32 s64, 0
  s_cbranch_scc1 L_arr_8
  s_and_b32 s3, s2, 3
  s_lshl_b32 s3, s3, 6
  v_mov_b32 v8, s3
  v_mov_b32 v9, 1
  s_mov_b32 exec_lo, 1
  s_mov_b32 exec_hi, 0
  global_atomic_add v8, v9, s[34:35] sc1
  s_mov_b64 exec, -1
L_arr_8:
  s_mov_b32 exec_hi, 0x00ffffff
  s_add_u32 m0, s93, 14336
  s_add_u32 s91, s92, 14336
  buffer_load_dwordx4 v230, s[40:43], s91 offen lds
  s_add_u32 m0, s93, 15232
  s_add_u32 s91, s92, 15232
  buffer_load_dwordx4 v230, s[40:43], s91 offen lds
  s_add_u32 m0, s93, 16128
  s_add_u32 s91, s92, 16128
  buffer_load_dwordx4 v231, s[40:43], s91 offen lds
  s_add_u32 m0, s93, 17024
  s_add_u32 s91, s92, 17024
  buffer_load_dwordx4 v231, s[40:43], s91 offen lds
  s_add_u32 m0, s93, 28672
  s_add_u32 s91, s92, 28672
  buffer_load_dwordx4 v232, s[40:43], s91 offen lds
  s_add_u32 m0, s93, 29568
  s_add_u32 s91, s92, 29568
  buffer_load_dwordx4 v232, s[40:43], s91 offen lds
  s_add_u32 m0, s93, 30464
  s_add_u32 s91, s92, 30464
  buffer_load_dwordx4 v233, s[40:43], s91 offen lds
  s_add_u32 m0, s93, 31360
  s_add_u32 s91, s92, 31360
  buffer_load_dwordx4 v233, s[40:43], s91 offen lds
  s_mov_b32 exec_hi, 0x000fffff
  s_add_u32 m0, s84, 0
  s_add_u32 s91, s89, 0
  buffer_load_dwordx4 v224, s[48:51], s91 offen lds
  s_add_u32 m0, s84, 832
  s_add_u32 s91, s89, 896
  buffer_load_dwordx4 v224, s[48:51], s91 offen lds
  s_add_u32 m0, s84, 1664
  s_add_u32 s91, s89, 1792
  buffer_load_dwordx4 v224, s[48:51], s91 offen lds
  s_add_u32 m0, s84, 2496
  s_add_u32 s91, s89, 2688
  buffer_load_dwordx4 v224, s[48:51], s91 offen lds
  s_add_u32 m0, s84, 3328
  s_add_u32 s91, s89, 3584
  buffer_load_dwordx4 v225, s[48:51], s91 offen lds
  s_add_u32 m0, s84, 4160
  s_add_u32 s91, s89, 4480
  buffer_load_dwordx4 v225, s[48:51], s91 offen lds
  s_add_u32 m0, s84, 4992
  s_add_u32 s91, s89, 5376
  buffer_load_dwordx4 v225, s[48:51], s91 offen lds
  s_add_u32 m0, s84, 5824
  s_add_u32 s91, s89, 6272
  buffer_load_dwordx4 v225, s[48:51], s91 offen lds
  s_add_u32 m0, s84, 6656
  s_add_u32 s91, s89, 7168
  buffer_load_dwordx4 v226, s[48:51], s91 offen lds
  s_add_u32 m0, s84, 7488
  s_add_u32 s91, s89, 8064
  buffer_load_dwordx4 v226, s[48:51], s91 offen lds
  s_add_u32 m0, s84, 8320
  s_add_u32 s91, s89, 8960
  buffer_load_dwordx4 v226, s[48:51], s91 offen lds
  s_add_u32 m0, s84, 9152
  s_add_u32 s91, s89, 9856
  buffer_load_dwordx4 v226, s[48:51], s91 offen lds
  s_add_u32 m0, s84, 9984
  s_add_u32 s91, s89, 10752
  buffer_load_dwordx4 v227, s[48:51], s91 offen lds
  s_add_u32 m0, s84, 10816
  s_add_u32 s91, s89, 11648
  buffer_load_dwordx4 v227, s[48:51], s91 offen lds
  s_add_u32 m0, s84, 11648
  s_add_u32 s91, s89, 12544
  buffer_load_dwordx4 v227, s[48:51], s91 offen lds
  s_add_u32 m0, s84, 12480
  s_add_u32 s91, s89, 13440
  buffer_load_dwordx4 v227, s[48:51], s91 offen lds
  s_add_u32 m0, s84, 13312
  s_add_u32 s91, s89, 0
  buffer_load_dwordx4 v224, s[52:55], s91 offen lds
  s_add_u32 m0, s84, 14144
  s_add_u32 s91, s89, 896
  buffer_load_dwordx4 v224, s[52:55], s91 offen lds
  s_add_u32 m0, s84, 14976
  s_add_u32 s91, s89, 1792
  buffer_load_dwordx4 v224, s[52:55], s91 offen lds
  s_add_u32 m0, s84, 15808
  s_add_u32 s91, s89, 2688
  buffer_load_dwordx4 v224, s[52:55], s91 offen lds
  s_add_u32 m0, s84, 16640
  s_add_u32 s91, s89, 3584
  buffer_load_dwordx4 v225, s[52:55], s91 offen lds
  s_add_u32 m0, s84, 17472
  s_add_u32 s91, s89, 4480
  buffer_load_dwordx4 v225, s[52:55], s91 offen lds
  s_add_u32 m0, s84, 18304
  s_add_u32 s91, s89, 5376
  buffer_load_dwordx4 v225, s[52:55], s91 offen lds
  s_add_u32 m0, s84, 19136
  s_add_u32 s91, s89, 6272
  buffer_load_dwordx4 v225, s[52:55], s91 offen lds
  s_add_u32 m0, s84, 19968
  s_add_u32 s91, s89, 7168
  buffer_load_dwordx4 v226, s[52:55], s91 offen lds
  s_add_u32 m0, s84, 20800
  s_add_u32 s91, s89, 8064
  buffer_load_dwordx4 v226, s[52:55], s91 offen lds
  s_add_u32 m0, s84, 21632
  s_add_u32 s91, s89, 8960
  buffer_load_dwordx4 v226, s[52:55], s91 offen lds
  s_add_u32 m0, s84, 22464
  s_add_u32 s91, s89, 9856
  buffer_load_dwordx4 v226, s[52:55], s91 offen lds
  s_add_u32 m0, s84, 23296
  s_add_u32 s91, s89, 10752
  buffer_load_dwordx4 v227, s[52:55], s91 offen lds
  s_add_u32 m0, s84, 24128
  s_add_u32 s91, s89, 11648
  buffer_load_dwordx4 v227, s[52:55], s91 offen lds
  s_add_u32 m0, s84, 24960
  s_add_u32 s91, s89, 12544
  buffer_load_dwordx4 v227, s[52:55], s91 offen lds
  s_add_u32 m0, s84, 25792
  s_add_u32 s91, s89, 13440
  buffer_load_dwordx4 v227, s[52:55], s91 offen lds
  s_mov_b32 exec_hi, -1
  buffer_load_dwordx4 v[164:167], v236, s[48:51], s89 offen offset:832
  buffer_load_dwordx4 v[220:223], v236, s[52:55], s89 offen offset:832
  v_lshrrev_b32 v7, 3, v0
  v_and_b32 v8, 7, v0
  v_min_u32 v8, 6, v8
  v_mul_u32_u24 v7, 3584, v7
  v_lshlrev_b32 v8, 7, v8
  v_add_u32 v7, v7, v8
  s_lshl_b32 s79, s64, 9
  s_and_b32 s81, s95, 1
  s_lshl_b32 s80, s86, 3
  s_add_u32 s79, s79, s80
  s_lshl_b32 s80, s81, 2
  s_add_u32 s79, s79, s80
  s_mul_i32 s79, s79, 3584
  s_lshl_b32 s80, s87, 7
  s_add_u32 s79, s79, s80
  s_mov_b32 exec_lo, -1
  s_mov_b32 exec_hi, 0
  buffer_load_dword v12, v7, s[56:59], s79 offen
  s_mov_b64 exec, -1
  s_waitcnt vmcnt(3)
  s_barrier
  v_and_b32 v7, 15, v0
  v_lshrrev_b32 v8, 4, v0
  v_lshrrev_b32 v9, 2, v7
  v_sub_u32 v9, 0, v9
  v_and_b32 v9, 3, v9
  v_xor_b32 v8, v8, v9
  v_lshlrev_b32 v8, 4, v8
  v_mul_u32_u24 v7, 832, v7
  v_add_u32 v7, v7, v8
  v_add_u32 v7, s84, v7
  ds_read_b128 v[112:115], v7 offset:0
  ds_read_b128 v[116:119], v7 offset:64
  ds_read_b128 v[120:123], v7 offset:128
  ds_read_b128 v[124:127], v7 offset:192
  ds_read_b128 v[128:131], v7 offset:256
  ds_read_b128 v[132:135], v7 offset:320
  ds_read_b128 v[136:139], v7 offset:384
  ds_read_b128 v[140:143], v7 offset:448
  ds_read_b128 v[144:147], v7 offset:512
  ds_read_b128 v[148:151], v7 offset:576
  ds_read_b128 v[152:155], v7 offset:640
  ds_read_b128 v[156:159], v7 offset:704
  ds_read_b128 v[160:163], v7 offset:768
  ds_read_b128 v[168:171], v7 offset:13312
  ds_read_b128 v[172:175], v7 offset:13376
  ds_read_b128 v[176:179], v7 offset:13440
  ds_read_b128 v[180:183], v7 offset:13504
  ds_read_b128 v[184:187], v7 offset:13568
  ds_read_b128 v[188:191], v7 offset:13632
  ds_read_b128 v[192:195], v7 offset:13696
  ds_read_b128 v[196:199], v7 offset:13760
  ds_read_b128 v[200:203], v7 offset:13824
  ds_read_b128 v[204:207], v7 offset:13888
  ds_read_b128 v[208:211], v7 offset:13952
  ds_read_b128 v[212:215], v7 offset:14016
  ds_read_b128 v[216:219], v7 offset:14080
  s_waitcnt lgkmcnt(0)
  s_mul_i32 s79, s64, 3584
  v_add_u32 v22, s79, v14
  v_add_u32 v23, s79, v15
  ds_read_b128 v[56:59], v22 offset:0
  ds_read_b128 v[60:63], v23 offset:0
  ds_read_b128 v[64:67], v22 offset:128
  ds_read_b128 v[68:71], v23 offset:128
  ds_read_b128 v[72:75], v22 offset:256
  ds_read_b128 v[76:79], v23 offset:256
  ds_read_b128 v[80:83], v22 offset:384
  ds_read_b128 v[84:87], v23 offset:384
  ds_read_b128 v[88:91], v22 offset:512
  ds_read_b128 v[92:95], v23 offset:512
  ds_read_b128 v[96:99], v22 offset:640
  ds_read_b128 v[100:103], v23 offset:640
  ds_read_b128 v[104:107], v22 offset:768
  ds_read_b128 v[108:111], v23 offset:768
  s_waitcnt lgkmcnt(13)
  v_dot2_f32_bf16 v24, v56, s73, 0
  v_dot2_f32_bf16 v25, v56, v56, 0
  v_dot2_f32_bf16 v26, v57, s73, 0
  v_dot2_f32_bf16 v27, v57, v57, 0
  v_dot2_f32_bf16 v24, v58, s73, v24
  v_dot2_f32_bf16 v25, v58, v58, v25
  v_dot2_f32_bf16 v26, v59, s73, v26
  v_dot2_f32_bf16 v27, v59, v59, v27
  s_waitcnt lgkmcnt(12)
  v_dot2_f32_bf16 v24, v60, s73, v24
  v_dot2_f32_bf16 v25, v60, v60, v25
  v_dot2_f32_bf16 v26, v61, s73, v26
  v_dot2_f32_bf16 v27, v61, v61, v27
  v_dot2_f32_bf16 v24, v62, s73, v24
  v_dot2_f32_bf16 v25, v62, v62, v25
  v_dot2_f32_bf16 v26, v63, s73, v26
  v_dot2_f32_bf16 v27, v63, v63, v27
  s_waitcnt lgkmcnt(11)
  v_dot2_f32_bf16 v24, v64, s73, v24
  v_dot2_f32_bf16 v25, v64, v64, v25
  v_dot2_f32_bf16 v26, v65, s73, v26
  v_dot2_f32_bf16 v27, v65, v65, v27
  v_dot2_f32_bf16 v24, v66, s73, v24
  v_dot2_f32_bf16 v25, v66, v66, v25
  v_dot2_f32_bf16 v26, v67, s73, v26
  v_dot2_f32_bf16 v27, v67, v67, v27
  s_waitcnt lgkmcnt(10)
  v_dot2_f32_bf16 v24, v68, s73, v24
  v_dot2_f32_bf16 v25, v68, v68, v25
  v_dot2_f32_bf16 v26, v69, s73, v26
  v_dot2_f32_bf16 v27, v69, v69, v27
  v_dot2_f32_bf16 v24, v70, s73, v24
  v_dot2_f32_bf16 v25, v70, v70, v25
  v_dot2_f32_bf16 v26, v71, s73, v26
  v_dot2_f32_bf16 v27, v71, v71, v27
  s_waitcnt lgkmcnt(9)
  v_dot2_f32_bf16 v24, v72, s73, v24
  v_dot2_f32_bf16 v25, v72, v72, v25
  v_dot2_f32_bf16 v26, v73, s73, v26
  v_dot2_f32_bf16 v27, v73, v73, v27
  v_dot2_f32_bf16 v24, v74, s73, v24
  v_dot2_f32_bf16 v25, v74, v74, v25
  v_dot2_f32_bf16 v26, v75, s73, v26
  v_dot2_f32_bf16 v27, v75, v75, v27
  s_waitcnt lgkmcnt(8)
  v_dot2_f32_bf16 v24, v76, s73, v24
  v_dot2_f32_bf16 v25, v76, v76, v25
  v_dot2_f32_bf16 v26, v77, s73, v26
  v_dot2_f32_bf16 v27, v77, v77, v27
  v_dot2_f32_bf16 v24, v78, s73, v24
  v_dot2_f32_bf16 v25, v78, v78, v25
  v_dot2_f32_bf16 v26, v79, s73, v26
  v_dot2_f32_bf16 v27, v79, v79, v27
  s_waitcnt lgkmcnt(7)
  v_dot2_f32_bf16 v24, v80, s73, v24
  v_dot2_f32_bf16 v25, v80, v80, v25
  v_dot2_f32_bf16 v26, v81, s73, v26
  v_dot2_f32_bf16 v27, v81, v81, v27
  v_dot2_f32_bf16 v24, v82, s73, v24
  v_dot2_f32_bf16 v25, v82, v82, v25
  v_dot2_f32_bf16 v26, v83, s73, v26
  v_dot2_f32_bf16 v27, v83, v83, v27
  s_waitcnt lgkmcnt(6)
  v_dot2_f32_bf16 v24, v84, s73, v24
  v_dot2_f32_bf16 v25, v84, v84, v25
  v_dot2_f32_bf16 v26, v85, s73, v26
  v_dot2_f32_bf16 v27, v85, v85, v27
  v_dot2_f32_bf16 v24, v86, s73, v24
  v_dot2_f32_bf16 v25, v86, v86, v25
  v_dot2_f32_bf16 v26, v87, s73, v26
  v_dot2_f32_bf16 v27, v87, v87, v27
  s_waitcnt lgkmcnt(5)
  v_dot2_f32_bf16 v24, v88, s73, v24
  v_dot2_f32_bf16 v25, v88, v88, v25
  v_dot2_f32_bf16 v26, v89, s73, v26
  v_dot2_f32_bf16 v27, v89, v89, v27
  v_dot2_f32_bf16 v24, v90, s73, v24
  v_dot2_f32_bf16 v25, v90, v90, v25
  v_dot2_f32_bf16 v26, v91, s73, v26
  v_dot2_f32_bf16 v27, v91, v91, v27
  s_waitcnt lgkmcnt(4)
  v_dot2_f32_bf16 v24, v92, s73, v24
  v_dot2_f32_bf16 v25, v92, v92, v25
  v_dot2_f32_bf16 v26, v93, s73, v26
  v_dot2_f32_bf16 v27, v93, v93, v27
  v_dot2_f32_bf16 v24, v94, s73, v24
  v_dot2_f32_bf16 v25, v94, v94, v25
  v_dot2_f32_bf16 v26, v95, s73, v26
  v_dot2_f32_bf16 v27, v95, v95, v27
  s_waitcnt lgkmcnt(3)
  v_dot2_f32_bf16 v24, v96, s73, v24
  v_dot2_f32_bf16 v25, v96, v96, v25
  v_dot2_f32_bf16 v26, v97, s73, v26
  v_dot2_f32_bf16 v27, v97, v97, v27
  v_dot2_f32_bf16 v24, v98, s73, v24
  v_dot2_f32_bf16 v25, v98, v98, v25
  v_dot2_f32_bf16 v26, v99, s73, v26
  v_dot2_f32_bf16 v27, v99, v99, v27
  s_waitcnt lgkmcnt(2)
  v_dot2_f32_bf16 v24, v100, s73, v24
  v_dot2_f32_bf16 v25, v100, v100, v25
  v_dot2_f32_bf16 v26, v101, s73, v26
  v_dot2_f32_bf16 v27, v101, v101, v27
  v_dot2_f32_bf16 v24, v102, s73, v24
  v_dot2_f32_bf16 v25, v102, v102, v25
  v_dot2_f32_bf16 v26, v103, s73, v26
  v_dot2_f32_bf16 v27, v103, v103, v27
  s_waitcnt lgkmcnt(1)
  v_dot2_f32_bf16 v24, v104, s73, v24
  v_dot2_f32_bf16 v25, v104, v104, v25
  v_dot2_f32_bf16 v26, v105, s73, v26
  v_dot2_f32_bf16 v27, v105, v105, v27
  v_dot2_f32_bf16 v24, v106, s73, v24
  v_dot2_f32_bf16 v25, v106, v106, v25
  v_dot2_f32_bf16 v26, v107, s73, v26
  v_dot2_f32_bf16 v27, v107, v107, v27
  s_waitcnt lgkmcnt(0)
  v_dot2_f32_bf16 v24, v108, s73, v24
  v_dot2_f32_bf16 v25, v108, v108, v25
  v_dot2_f32_bf16 v26, v109, s73, v26
  v_dot2_f32_bf16 v27, v109, v109, v27
  v_dot2_f32_bf16 v24, v110, s73, v24
  v_dot2_f32_bf16 v25, v110, v110, v25
  v_dot2_f32_bf16 v26, v111, s73, v26
  v_dot2_f32_bf16 v27, v111, v111, v27
  s_nop 1
  v_add_f32 v24, v24, v26
  v_add_f32 v25, v25, v27
  v_mov_b32 v26, v24
  v_mov_b32 v27, v25
  s_nop 0
  v_permlane16_swap_b32 v24, v26
  v_permlane16_swap_b32 v25, v27
  v_add_f32 v24, v24, v26
  v_add_f32 v25, v25, v27
  v_mov_b32 v26, v24
  v_mov_b32 v27, v25
  s_nop 0
  v_permlane32_swap_b32 v24, v26
  v_permlane32_swap_b32 v25, v27
  v_add_f32 v24, v24, v26
  v_add_f32 v25, v25, v27
  v_mul_f32 v24, 0x3b124925, v24
  v_mul_f32 v25, 0x3b124925, v25
  v_fma_f32 v25, -v24, v24, v25
  v_max_f32 v25, 0, v25
  v_cvt_pk_bf16_f32 v24, v24, v24
  v_cvt_pk_bf16_f32 v25, v25, v25
  v_lshlrev_b32 v24, 16, v24
  v_lshlrev_b32 v25, 16, v25
  v_add_f32 v25, 0x3727c5ac, v25
  v_cvt_pk_bf16_f32 v25, v25, v25
  v_lshlrev_b32 v25, 16, v25
  v_sqrt_f32 v25, v25
  s_nop 0
  v_cvt_pk_bf16_f32 v25, v25, v25
  v_lshlrev_b32 v25, 16, v25
  v_rcp_f32 v28, v25
  s_nop 0
  v_mul_f32 v30, v24, v28
  v_sub_f32 v30, 0, v30
  v_and_b32 v8, 15, v0
  v_lshlrev_b32 v8, 2, v8
  s_add_u32 s79, s84, 24576
  v_add_u32 v8, s79, v8
  s_mov_b32 exec_lo, 0xffff
  s_mov_b32 exec_hi, 0
  ds_write_b32 v8, v24
  ds_write_b32 v8, v28 offset:64
  s_mov_b64 exec, -1
  s_waitcnt vmcnt(1)
  v_and_b32 v35, 3, v0
  v_lshlrev_b32 v35, 6, v35
  global_load_dword v34, v35, s[34:35] sc1
  v_mov_b32 v36, s73
  v_mov_b32 v37, s73
  v_mov_b32 v38, s73
  v_mov_b32 v39, s73
  ds_read_b128 v[56:59], v14 offset:0
  ds_read_b128 v[60:63], v14 offset:3584
  ds_read_b128 v[64:67], v14 offset:7168
  ds_read_b128 v[68:71], v14 offset:10752
  ds_read_b128 v[72:75], v15 offset:0
  ds_read_b128 v[76:79], v15 offset:3584
  ds_read_b128 v[80:83], v15 offset:7168
  ds_read_b128 v[84:87], v15 offset:10752
  s_add_u32 m0, s84, 0
  s_nop 0
  buffer_load_dwordx4 v6, s[56:59], s78 offen offset:0 lds
  s_waitcnt lgkmcnt(4)
  v_mfma_f32_16x16x32_bf16 v[104:107], v[36:39], v[112:115], 0
  v_mfma_f32_16x16x32_bf16 v[108:111], v[36:39], v[168:171], 0
  v_mfma_f32_16x16x32_bf16 v[224:227], v[56:59], v[112:115], 0
  buffer_load_dwordx4 v13, s[56:59], s78 offen offset:1024 lds
  v_mfma_f32_16x16x32_bf16 v[240:243], v[56:59], v[168:171], 0
  v_mfma_f32_16x16x32_bf16 v[228:231], v[60:63], v[112:115], 0
  v_mfma_f32_16x16x32_bf16 v[244:247], v[60:63], v[168:171], 0
  s_add_u32 m0, s84, 2048
  s_add_u32 s78, s78, 57344
  buffer_load_dwordx4 v6, s[56:59], s78 offen offset:0 lds
  v_mfma_f32_16x16x32_bf16 v[232:235], v[64:67], v[112:115], 0
  v_mfma_f32_16x16x32_bf16 v[248:251], v[64:67], v[168:171], 0
  v_mfma_f32_16x16x32_bf16 v[236:239], v[68:71], v[112:115], 0
  buffer_load_dwordx4 v13, s[56:59], s78 offen offset:1024 lds
  v_mfma_f32_16x16x32_bf16 v[252:255], v[68:71], v[168:171], 0
  ds_read_b128 v[56:59], v14 offset:128
  ds_read_b128 v[60:63], v14 offset:3712
  ds_read_b128 v[64:67], v14 offset:7296
  ds_read_b128 v[68:71], v14 offset:10880
  s_waitcnt lgkmcnt(4)
  v_mfma_f32_16x16x32_bf16 v[104:107], v[36:39], v[116:119], v[104:107]
  s_add_u32 m0, s84, 4096
  s_add_u32 s78, s78, 57344
  buffer_load_dwordx4 v6, s[56:59], s78 offen offset:0 lds
  v_mfma_f32_16x16x32_bf16 v[108:111], v[36:39], v[172:175], v[108:111]
  v_mfma_f32_16x16x32_bf16 v[224:227], v[72:75], v[116:119], v[224:227]
  v_mfma_f32_16x16x32_bf16 v[240:243], v[72:75], v[172:175], v[240:243]
  buffer_load_dwordx4 v13, s[56:59], s78 offen offset:1024 lds
  v_mfma_f32_16x16x32_bf16 v[228:231], v[76:79], v[116:119], v[228:231]
  v_mfma_f32_16x16x32_bf16 v[244:247], v[76:79], v[172:175], v[244:247]
  v_mfma_f32_16x16x32_bf16 v[232:235], v[80:83], v[116:119], v[232:235]
  s_add_u32 m0, s84, 6144
  s_add_u32 s78, s78, 57344
  buffer_load_dwordx4 v6, s[56:59], s78 offen offset:0 lds
  v_mfma_f32_16x16x32_bf16 v[248:251], v[80:83], v[172:175], v[248:251]
  v_mfma_f32_16x16x32_bf16 v[236:239], v[84:87], v[116:119], v[236:239]
  v_mfma_f32_16x16x32_bf16 v[252:255], v[84:87], v[172:175], v[252:255]
  buffer_load_dwordx4 v13, s[56:59], s78 offen offset:1024 lds
  ds_read_b128 v[72:75], v15 offset:128
  ds_read_b128 v[76:79], v15 offset:3712
  ds_read_b128 v[80:83], v15 offset:7296
  ds_read_b128 v[84:87], v15 offset:10880
  s_waitcnt lgkmcnt(4)
  v_mfma_f32_16x16x32_bf16 v[104:107], v[36:39], v[120:123], v[104:107]
  v_mfma_f32_16x16x32_bf16 v[108:111], v[36:39], v[176:179], v[108:111]
  s_add_u32 m0, s84, 8192
  s_add_u32 s78, s78, 57344
  buffer_load_dwordx4 v6, s[56:59], s78 offen offset:0 lds
  v_mfma_f32_16x16x32_bf16 v[224:227], v[56:59], v[120:123], v[224:227]
  v_mfma_f32_16x16x32_bf16 v[240:243], v[56:59], v[176:179], v[240:243]
  v_mfma_f32_16x16x32_bf16 v[228:231], v[60:63], v[120:123], v[228:231]
  buffer_load_dwordx4 v13, s[56:59], s78 offen offset:1024 lds
  v_mfma_f32_16x16x32_bf16 v[244:247], v[60:63], v[176:179], v[244:247]
  v_mfma_f32_16x16x32_bf16 v[232:235], v[64:67], v[120:123], v[232:235]
  v_mfma_f32_16x16x32_bf16 v[248:251], v[64:67], v[176:179], v[248:251]
  s_add_u32 m0, s84, 10240
  s_add_u32 s78, s78, 57344
  buffer_load_dwordx4 v6, s[56:59], s78 offen offset:0 lds
  v_mfma_f32_16x16x32_bf16 v[236:239], v[68:71], v[120:123], v[236:239]
  v_mfma_f32_16x16x32_bf16 v[252:255], v[68:71], v[176:179], v[252:255]
  ds_read_b128 v[56:59], v14 offset:256
  ds_read_b128 v[60:63], v14 offset:3840
  ds_read_b128 v[64:67], v14 offset:7424
  ds_read_b128 v[68:71], v14 offset:11008
  buffer_load_dwordx4 v13, s[56:59], s78 offen offset:1024 lds
  s_waitcnt lgkmcnt(4)
  v_mfma_f32_16x16x32_bf16 v[104:107], v[36:39], v[124:127], v[104:107]
  v_mfma_f32_16x16x32_bf16 v[108:111], v[36:39], v[180:183], v[108:111]
  v_mfma_f32_16x16x32_bf16 v[224:227], v[72:75], v[124:127], v[224:227]
  s_add_u32 m0, s84, 12288
  s_add_u32 s78, s78, 57344
  buffer_load_dwordx4 v6, s[56:59], s78 offen offset:0 lds
  v_mfma_f32_16x16x32_bf16 v[240:243], v[72:75], v[180:183], v[240:243]
  v_mfma_f32_16x16x32_bf16 v[228:231], v[76:79], v[124:127], v[228:231]
  v_mfma_f32_16x16x32_bf16 v[244:247], v[76:79], v[180:183], v[244:247]
  buffer_load_dwordx4 v13, s[56:59], s78 offen offset:1024 lds
  v_mfma_f32_16x16x32_bf16 v[232:235], v[80:83], v[124:127], v[232:235]
  v_mfma_f32_16x16x32_bf16 v[248:251], v[80:83], v[180:183], v[248:251]
  v_mfma_f32_16x16x32_bf16 v[236:239], v[84:87], v[124:127], v[236:239]
  s_add_u32 m0, s84, 14336
  s_add_u32 s78, s78, 57344
  buffer_load_dwordx4 v6, s[56:59], s78 offen offset:0 lds
  v_mfma_f32_16x16x32_bf16 v[252:255], v[84:87], v[180:183], v[252:255]
  ds_read_b128 v[72:75], v15 offset:256
  ds_read_b128 v[76:79], v15 offset:3840
  ds_read_b128 v[80:83], v15 offset:7424
  ds_read_b128 v[84:87], v15 offset:11008
  s_waitcnt lgkmcnt(4)
  v_mfma_f32_16x16x32_bf16 v[104:107], v[36:39], v[128:131], v[104:107]
  buffer_load_dwordx4 v13, s[56:59], s78 offen offset:1024 lds
  v_mfma_f32_16x16x32_bf16 v[108:111], v[36:39], v[184:187], v[108:111]
  v_mfma_f32_16x16x32_bf16 v[224:227], v[56:59], v[128:131], v[224:227]
  v_mfma_f32_16x16x32_bf16 v[240:243], v[56:59], v[184:187], v[240:243]
  s_add_u32 m0, s84, 16384
  s_add_u32 s78, s78, 57344
  buffer_load_dwordx4 v6, s[56:59], s78 offen offset:0 lds
  v_mfma_f32_16x16x32_bf16 v[228:231], v[60:63], v[128:131], v[228:231]
  v_mfma_f32_16x16x32_bf16 v[244:247], v[60:63], v[184:187], v[244:247]
  v_mfma_f32_16x16x32_bf16 v[232:235], v[64:67], v[128:131], v[232:235]
  buffer_load_dwordx4 v13, s[56:59], s78 offen offset:1024 lds
  v_mfma_f32_16x16x32_bf16 v[248:251], v[64:67], v[184:187], v[248:251]
  v_mfma_f32_16x16x32_bf16 v[236:239], v[68:71], v[128:131], v[236:239]
  v_mfma_f32_16x16x32_bf16 v[252:255], v[68:71], v[184:187], v[252:255]
  s_add_u32 m0, s84, 18432
  s_add_u32 s78, s78, 57344
  buffer_load_dwordx4 v6, s[56:59], s78 offen offset:0 lds
  ds_read_b128 v[56:59], v14 offset:384
  ds_read_b128 v[60:63], v14 offset:3968
  ds_read_b128 v[64:67], v14 offset:7552
  ds_read_b128 v[68:71], v14 offset:11136
  s_waitcnt lgkmcnt(4)
  v_mfma_f32_16x16x32_bf16 v[104:107], v[36:39], v[132:135], v[104:107]
  v_mfma_f32_16x16x32_bf16 v[108:111], v[36:39], v[188:191], v[108:111]
  buffer_load_dwordx4 v13, s[56:59], s78 offen offset:1024 lds
  v_mfma_f32_16x16x32_bf16 v[224:227], v[72:75], v[132:135], v[224:227]
  v_mfma_f32_16x16x32_bf16 v[240:243], v[72:75], v[188:191], v[240:243]
  v_mfma_f32_16x16x32_bf16 v[228:231], v[76:79], v[132:135], v[228:231]
  s_add_u32 m0, s84, 20480
  s_add_u32 s78, s78, 57344
  buffer_load_dwordx4 v6, s[56:59], s78 offen offset:0 lds
  v_mfma_f32_16x16x32_bf16 v[244:247], v[76:79], v[188:191], v[244:247]
  v_mfma_f32_16x16x32_bf16 v[232:235], v[80:83], v[132:135], v[232:235]
  v_mfma_f32_16x16x32_bf16 v[248:251], v[80:83], v[188:191], v[248:251]
  buffer_load_dwordx4 v13, s[56:59], s78 offen offset:1024 lds
  v_mfma_f32_16x16x32_bf16 v[236:239], v[84:87], v[132:135], v[236:239]
  v_mfma_f32_16x16x32_bf16 v[252:255], v[84:87], v[188:191], v[252:255]
  ds_read_b128 v[72:75], v15 offset:384
  ds_read_b128 v[76:79], v15 offset:3968
  ds_read_b128 v[80:83], v15 offset:7552
  ds_read_b128 v[84:87], v15 offset:11136
  s_add_u32 m0, s84, 22528
  s_add_u32 s78, s78, 57344
  buffer_load_dwordx4 v6, s[56:59], s78 offen offset:0 lds
  s_waitcnt vmcnt(19)
  ds_read_b64_tr_b16 a[0:1], v2 offset:0
  ds_read_b64_tr_b16 a[2:3], v2 offset:2048
  ds_read_b64_tr_b16 a[4:5], v3 offset:0
  ds_read_b64_tr_b16 a[6:7], v3 offset:2048
  ds_read_b64_tr_b16 a[8:9], v4 offset:0
  ds_read_b64_tr_b16 a[10:11], v4 offset:2048
  ds_read_b64_tr_b16 a[12:13], v5 offset:0
  ds_read_b64_tr_b16 a[14:15], v5 offset:2048
  s_waitcnt lgkmcnt(12)
  v_mfma_f32_16x16x32_bf16 v[104:107], v[36:39], v[136:139], v[104:107]
  v_mfma_f32_16x16x32_bf16 v[108:111], v[36:39], v[192:195], v[108:111]
  v_mfma_f32_16x16x32_bf16 v[224:227], v[56:59], v[136:139], v[224:227]
  buffer_load_dwordx4 v13, s[56:59], s78 offen offset:1024 lds
  v_mfma_f32_16x16x32_bf16 v[240:243], v[56:59], v[192:195], v[240:243]
  v_mfma_f32_16x16x32_bf16 v[228:231], v[60:63], v[136:139], v[228:231]
  v_mfma_f32_16x16x32_bf16 v[244:247], v[60:63], v[192:195], v[244:247]
  s_waitcnt lgkmcnt(0)
  s_add_u32 m0, s84, 0
  s_add_u32 s78, s78, 57344
  buffer_load_dwordx4 v6, s[56:59], s78 offen offset:0 lds
  v_mfma_f32_16x16x32_bf16 v[232:235], v[64:67], v[136:139], v[232:235]
  v_mfma_f32_16x16x32_bf16 v[248:251], v[64:67], v[192:195], v[248:251]
  v_mfma_f32_16x16x32_bf16 v[236:239], v[68:71], v[136:139], v[236:239]
  buffer_load_dwordx4 v13, s[56:59], s78 offen offset:1024 lds
  v_mfma_f32_16x16x32_bf16 v[252:255], v[68:71], v[192:195], v[252:255]
  ds_read_b128 v[56:59], v14 offset:512
  ds_read_b128 v[60:63], v14 offset:4096
  ds_read_b128 v[64:67], v14 offset:7680
  ds_read_b128 v[68:71], v14 offset:11264
  v_mfma_f32_16x16x32_bf16 v[104:107], v[36:39], v[140:143], v[104:107]
  s_add_u32 m0, s84, 2048
  s_add_u32 s78, s78, 57344
  buffer_load_dwordx4 v6, s[56:59], s78 offen offset:0 lds
  s_waitcnt vmcnt(19)
  ds_read_b64_tr_b16 a[16:17], v2 offset:4096
  ds_read_b64_tr_b16 a[18:19], v2 offset:6144
  ds_read_b64_tr_b16 a[20:21], v3 offset:4096
  ds_read_b64_tr_b16 a[22:23], v3 offset:6144
  ds_read_b64_tr_b16 a[24:25], v4 offset:4096
  ds_read_b64_tr_b16 a[26:27], v4 offset:6144
  ds_read_b64_tr_b16 a[28:29], v5 offset:4096
  ds_read_b64_tr_b16 a[30:31], v5 offset:6144
  v_mfma_f32_16x16x32_bf16 v[108:111], v[36:39], v[196:199], v[108:111]
  v_mfma_f32_16x16x32_bf16 v[224:227], v[72:75], v[140:143], v[224:227]
  v_mfma_f32_16x16x32_bf16 v[240:243], v[72:75], v[196:199], v[240:243]
  buffer_load_dwordx4 v13, s[56:59], s78 offen offset:1024 lds
  v_mfma_f32_16x16x32_bf16 v[228:231], v[76:79], v[140:143], v[228:231]
  v_mfma_f32_16x16x32_bf16 v[244:247], v[76:79], v[196:199], v[244:247]
  v_mfma_f32_16x16x32_bf16 v[232:235], v[80:83], v[140:143], v[232:235]
  s_waitcnt lgkmcnt(0)
  s_add_u32 m0, s84, 4096
  s_add_u32 s78, s78, 57344
  buffer_load_dwordx4 v6, s[56:59], s78 offen offset:0 lds
  v_mfma_f32_16x16x32_bf16 v[248:251], v[80:83], v[196:199], v[248:251]
  v_mfma_f32_16x16x32_bf16 v[236:239], v[84:87], v[140:143], v[236:239]
  v_mfma_f32_16x16x32_bf16 v[252:255], v[84:87], v[196:199], v[252:255]
  buffer_load_dwordx4 v13, s[56:59], s78 offen offset:1024 lds
  ds_read_b128 v[72:75], v15 offset:512
  ds_read_b128 v[76:79], v15 offset:4096
  ds_read_b128 v[80:83], v15 offset:7680
  ds_read_b128 v[84:87], v15 offset:11264
  v_mfma_f32_16x16x32_bf16 v[104:107], v[36:39], v[144:147], v[104:107]
  v_mfma_f32_16x16x32_bf16 v[108:111], v[36:39], v[200:203], v[108:111]
  s_add_u32 m0, s84, 6144
  s_add_u32 s78, s78, 57344
  buffer_load_dwordx4 v6, s[56:59], s78 offen offset:0 lds
  s_waitcnt vmcnt(19)
  ds_read_b64_tr_b16 a[32:33], v2 offset:8192
  ds_read_b64_tr_b16 a[34:35], v2 offset:10240
  ds_read_b64_tr_b16 a[36:37], v3 offset:8192
  ds_read_b64_tr_b16 a[38:39], v3 offset:10240
  ds_read_b64_tr_b16 a[40:41], v4 offset:8192
  ds_read_b64_tr_b16 a[42:43], v4 offset:10240
  ds_read_b64_tr_b16 a[44:45], v5 offset:8192
  ds_read_b64_tr_b16 a[46:47], v5 offset:10240
  v_mfma_f32_16x16x32_bf16 v[224:227], v[56:59], v[144:147], v[224:227]
  v_mfma_f32_16x16x32_bf16 v[240:243], v[56:59], v[200:203], v[240:243]
  v_mfma_f32_16x16x32_bf16 v[228:231], v[60:63], v[144:147], v[228:231]
  buffer_load_dwordx4 v13, s[56:59], s78 offen offset:1024 lds
  v_mfma_f32_16x16x32_bf16 v[244:247], v[60:63], v[200:203], v[244:247]
  v_mfma_f32_16x16x32_bf16 v[232:235], v[64:67], v[144:147], v[232:235]
  v_mfma_f32_16x16x32_bf16 v[248:251], v[64:67], v[200:203], v[248:251]
  s_waitcnt lgkmcnt(0)
  s_add_u32 m0, s84, 8192
  s_add_u32 s78, s78, 57344
  buffer_load_dwordx4 v6, s[56:59], s78 offen offset:0 lds
  v_mfma_f32_16x16x32_bf16 v[236:239], v[68:71], v[144:147], v[236:239]
  v_mfma_f32_16x16x32_bf16 v[252:255], v[68:71], v[200:203], v[252:255]
  ds_read_b128 v[56:59], v14 offset:640
  ds_read_b128 v[60:63], v14 offset:4224
  ds_read_b128 v[64:67], v14 offset:7808
  ds_read_b128 v[68:71], v14 offset:11392
  buffer_load_dwordx4 v13, s[56:59], s78 offen offset:1024 lds
  v_mfma_f32_16x16x32_bf16 v[104:107], v[36:39], v[148:151], v[104:107]
  v_mfma_f32_16x16x32_bf16 v[108:111], v[36:39], v[204:207], v[108:111]
  v_mfma_f32_16x16x32_bf16 v[224:227], v[72:75], v[148:151], v[224:227]
  s_add_u32 m0, s84, 10240
  s_add_u32 s78, s78, 57344
  buffer_load_dwordx4 v6, s[56:59], s78 offen offset:0 lds
  s_waitcnt vmcnt(19)
  ds_read_b64_tr_b16 a[48:49], v2 offset:12288
  ds_read_b64_tr_b16 a[50:51], v2 offset:14336
  ds_read_b64_tr_b16 a[52:53], v3 offset:12288
  ds_read_b64_tr_b16 a[54:55], v3 offset:14336
  ds_read_b64_tr_b16 a[56:57], v4 offset:12288
  ds_read_b64_tr_b16 a[58:59], v4 offset:14336
  ds_read_b64_tr_b16 a[60:61], v5 offset:12288
  ds_read_b64_tr_b16 a[62:63], v5 offset:14336
  v_mfma_f32_16x16x32_bf16 v[240:243], v[72:75], v[204:207], v[240:243]
  v_mfma_f32_16x16x32_bf16 v[228:231], v[76:79], v[148:151], v[228:231]
  v_mfma_f32_16x16x32_bf16 v[244:247], v[76:79], v[204:207], v[244:247]
  buffer_load_dwordx4 v13, s[56:59], s78 offen offset:1024 lds
  v_mfma_f32_16x16x32_bf16 v[232:235], v[80:83], v[148:151], v[232:235]
  v_mfma_f32_16x16x32_bf16 v[248:251], v[80:83], v[204:207], v[248:251]
  v_mfma_f32_16x16x32_bf16 v[236:239], v[84:87], v[148:151], v[236:239]
  s_waitcnt lgkmcnt(0)
  s_add_u32 m0, s84, 12288
  s_add_u32 s78, s78, 57344
  buffer_load_dwordx4 v6, s[56:59], s78 offen offset:0 lds
  v_mfma_f32_16x16x32_bf16 v[252:255], v[84:87], v[204:207], v[252:255]
  ds_read_b128 v[72:75], v15 offset:640
  ds_read_b128 v[76:79], v15 offset:4224
  ds_read_b128 v[80:83], v15 offset:7808
  ds_read_b128 v[84:87], v15 offset:11392
  v_mfma_f32_16x16x32_bf16 v[104:107], v[36:39], v[152:155], v[104:107]
  buffer_load_dwordx4 v13, s[56:59], s78 offen offset:1024 lds
  v_mfma_f32_16x16x32_bf16 v[108:111], v[36:39], v[208:211], v[108:111]
  v_mfma_f32_16x16x32_bf16 v[224:227], v[56:59], v[152:155], v[224:227]
  v_mfma_f32_16x16x32_bf16 v[240:243], v[56:59], v[208:211], v[240:243]
  s_add_u32 m0, s84, 14336
  s_add_u32 s78, s78, 57344
  buffer_load_dwordx4 v6, s[56:59], s78 offen offset:0 lds
  s_waitcnt vmcnt(19)
  ds_read_b64_tr_b16 a[64:65], v2 offset:16384
  ds_read_b64_tr_b16 a[66:67], v2 offset:18432
  ds_read_b64_tr_b16 a[68:69], v3 offset:16384
  ds_read_b64_tr_b16 a[70:71], v3 offset:18432
  ds_read_b64_tr_b16 a[72:73], v4 offset:16384
  ds_read_b64_tr_b16 a[74:75], v4 offset:18432
  ds_read_b64_tr_b16 a[76:77], v5 offset:16384
  ds_read_b64_tr_b16 a[78:79], v5 offset:18432
  v_mfma_f32_16x16x32_bf16 v[228:231], v[60:63], v[152:155], v[228:231]
  v_mfma_f32_16x16x32_bf16 v[244:247], v[60:63], v[208:211], v[244:247]
  v_mfma_f32_16x16x32_bf16 v[232:235], v[64:67], v[152:155], v[232:235]
  buffer_load_dwordx4 v13, s[56:59], s78 offen offset:1024 lds
  v_mfma_f32_16x16x32_bf16 v[248:251], v[64:67], v[208:211], v[248:251]
  v_mfma_f32_16x16x32_bf16 v[236:239], v[68:71], v[152:155], v[236:239]
  v_mfma_f32_16x16x32_bf16 v[252:255], v[68:71], v[208:211], v[252:255]
  s_waitcnt lgkmcnt(0)
  s_add_u32 m0, s84, 16384
  s_add_u32 s78, s78, 57344
  buffer_load_dwordx4 v6, s[56:59], s78 offen offset:0 lds
  ds_read_b128 v[56:59], v14 offset:768
  ds_read_b128 v[60:63], v14 offset:4352
  ds_read_b128 v[64:67], v14 offset:7936
  ds_read_b128 v[68:71], v14 offset:11520
  v_mfma_f32_16x16x32_bf16 v[104:107], v[36:39], v[156:159], v[104:107]
  v_mfma_f32_16x16x32_bf16 v[108:111], v[36:39], v[212:215], v[108:111]
  buffer_load_dwordx4 v13, s[56:59], s78 offen offset:1024 lds
  v_mfma_f32_16x16x32_bf16 v[224:227], v[72:75], v[156:159], v[224:227]
  v_mfma_f32_16x16x32_bf16 v[240:243], v[72:75], v[212:215], v[240:243]
  v_mfma_f32_16x16x32_bf16 v[228:231], v[76:79], v[156:159], v[228:231]
  s_add_u32 m0, s84, 18432
  s_add_u32 s78, s78, 57344
  buffer_load_dwordx4 v6, s[56:59], s78 offen offset:0 lds
  s_waitcnt vmcnt(19)
  ds_read_b64_tr_b16 a[80:81], v2 offset:20480
  ds_read_b64_tr_b16 a[82:83], v2 offset:22528
  ds_read_b64_tr_b16 a[84:85], v3 offset:20480
  ds_read_b64_tr_b16 a[86:87], v3 offset:22528
  ds_read_b64_tr_b16 a[88:89], v4 offset:20480
  ds_read_b64_tr_b16 a[90:91], v4 offset:22528
  ds_read_b64_tr_b16 a[92:93], v5 offset:20480
  ds_read_b64_tr_b16 a[94:95], v5 offset:22528
  v_mfma_f32_16x16x32_bf16 v[244:247], v[76:79], v[212:215], v[244:247]
  v_mfma_f32_16x16x32_bf16 v[232:235], v[80:83], v[156:159], v[232:235]
  v_mfma_f32_16x16x32_bf16 v[248:251], v[80:83], v[212:215], v[248:251]
  buffer_load_dwordx4 v13, s[56:59], s78 offen offset:1024 lds
  v_mfma_f32_16x16x32_bf16 v[236:239], v[84:87], v[156:159], v[236:239]
  v_mfma_f32_16x16x32_bf16 v[252:255], v[84:87], v[212:215], v[252:255]
  ds_read_b128 v[72:75], v15 offset:768
  ds_read_b128 v[76:79], v15 offset:4352
  ds_read_b128 v[80:83], v15 offset:7936
  ds_read_b128 v[84:87], v15 offset:11520
  s_waitcnt lgkmcnt(4)
  s_add_u32 m0, s84, 20480
  s_add_u32 s78, s78, 57344
  buffer_load_dwordx4 v6, s[56:59], s78 offen offset:0 lds
  v_mfma_f32_16x16x32_bf16 v[104:107], v[36:39], v[160:163], v[104:107]
  v_mfma_f32_16x16x32_bf16 v[108:111], v[36:39], v[216:219], v[108:111]
  v_mfma_f32_16x16x32_bf16 v[224:227], v[56:59], v[160:163], v[224:227]
  buffer_load_dwordx4 v13, s[56:59], s78 offen offset:1024 lds
  v_mfma_f32_16x16x32_bf16 v[240:243], v[56:59], v[216:219], v[240:243]
  v_mfma_f32_16x16x32_bf16 v[228:231], v[60:63], v[160:163], v[228:231]
  v_mfma_f32_16x16x32_bf16 v[244:247], v[60:63], v[216:219], v[244:247]
  s_add_u32 m0, s84, 22528
  s_add_u32 s78, s78, 57344
  buffer_load_dwordx4 v6, s[56:59], s78 offen offset:0 lds
  s_waitcnt vmcnt(19)
  ds_read_b64_tr_b16 a[96:97], v2 offset:0
  ds_read_b64_tr_b16 a[98:99], v2 offset:2048
  ds_read_b64_tr_b16 a[100:101], v3 offset:0
  ds_read_b64_tr_b16 a[102:103], v3 offset:2048
  ds_read_b64_tr_b16 a[104:105], v4 offset:0
  ds_read_b64_tr_b16 a[106:107], v4 offset:2048
  ds_read_b64_tr_b16 a[108:109], v5 offset:0
  ds_read_b64_tr_b16 a[110:111], v5 offset:2048
  v_mfma_f32_16x16x32_bf16 v[232:235], v[64:67], v[160:163], v[232:235]
  v_mfma_f32_16x16x32_bf16 v[248:251], v[64:67], v[216:219], v[248:251]
  v_mfma_f32_16x16x32_bf16 v[236:239], v[68:71], v[160:163], v[236:239]
  buffer_load_dwordx4 v13, s[56:59], s78 offen offset:1024 lds
  v_mfma_f32_16x16x32_bf16 v[252:255], v[68:71], v[216:219], v[252:255]
  s_barrier
  v_lshrrev_b32 v8, 4, v0
  v_lshlrev_b32 v8, 4, v8
  v_add_u32 v8, 81920, v8
  v_add_u32 v9, 53248, v8
  ds_read_b128 v[16:19], v8 offset:0
  ds_read_b128 v[88:91], v8 offset:64
  ds_read_b128 v[20:23], v8 offset:26624
  ds_read_b128 v[92:95], v8 offset:26688
  ds_read_b128 v[24:27], v9 offset:0
  ds_read_b128 v[96:99], v9 offset:64
  ds_read_b128 v[28:31], v9 offset:26624
  ds_read_b128 v[100:103], v9 offset:26688
  v_mfma_f32_16x16x32_bf16 v[104:107], v[36:39], v[164:167], v[104:107]
  v_mfma_f32_16x16x32_bf16 v[108:111], v[36:39], v[220:223], v[108:111]
  s_waitcnt lgkmcnt(8)
  s_add_u32 m0, s84, 0
  s_add_u32 s78, s78, 57344
  buffer_load_dwordx4 v6, s[56:59], s78 offen offset:0 lds
  v_mfma_f32_16x16x32_bf16 v[224:227], v[72:75], v[164:167], v[224:227]
  v_mfma_f32_16x16x32_bf16 v[240:243], v[72:75], v[220:223], v[240:243]
  v_mfma_f32_16x16x32_bf16 v[228:231], v[76:79], v[164:167], v[228:231]
  buffer_load_dwordx4 v13, s[56:59], s78 offen offset:1024 lds
  v_mfma_f32_16x16x32_bf16 v[244:247], v[76:79], v[220:223], v[244:247]
  v_mfma_f32_16x16x32_bf16 v[232:235], v[80:83], v[164:167], v[232:235]
  v_mfma_f32_16x16x32_bf16 v[248:251], v[80:83], v[220:223], v[248:251]
  s_add_u32 m0, s84, 2048
  s_add_u32 s78, s78, 57344
  buffer_load_dwordx4 v6, s[56:59], s78 offen offset:0 lds
  s_waitcnt vmcnt(19)
  ds_read_b64_tr_b16 a[112:113], v2 offset:4096
  ds_read_b64_tr_b16 a[114:115], v2 offset:6144
  ds_read_b64_tr_b16 a[116:117], v3 offset:4096
  ds_read_b64_tr_b16 a[118:119], v3 offset:6144
  ds_read_b64_tr_b16 a[120:121], v4 offset:4096
  ds_read_b64_tr_b16 a[122:123], v4 offset:6144
  ds_read_b64_tr_b16 a[124:125], v5 offset:4096
  ds_read_b64_tr_b16 a[126:127], v5 offset:6144
  v_mfma_f32_16x16x32_bf16 v[236:239], v[84:87], v[164:167], v[236:239]
  v_mfma_f32_16x16x32_bf16 v[252:255], v[84:87], v[220:223], v[252:255]
  v_and_b32 v8, 15, v0
  v_lshrrev_b32 v9, 4, v0
  v_lshrrev_b32 v10, 1, v9
  v_bfe_u32 v11, v8, 1, 1
  v_xor_b32 v10, v10, v11
  s_xor_b32 s79, s65, s66
  s_lshl_b32 s79, s79, 2
  v_xor_b32 v10, s79, v10
  v_lshlrev_b32 v10, 4, v10
  v_and_b32 v9, 1, v9
  v_lshlrev_b32 v9, 3, v9
  v_add_u32 v10, v10, v9
  s_lshl_b32 s79, s66, 5
  v_add_u32 v8, s79, v8
  v_mul_u32_u24 v8, 896, v8
  v_add_u32 v8, v8, v10
  s_lshl_b32 s79, s68, 7
  v_add_u32 v8, s79, v8
  v_xor_b32 v9, 32, v8
  ds_read_b64 v[216:217], v8 offset:0
  ds_read_b64 v[218:219], v9 offset:0
  ds_read_b64 v[220:221], v9 offset:14336
  ds_read_b64 v[222:223], v8 offset:14336
  s_waitcnt lgkmcnt(12)
  v_pk_fma_f32 v[224:225], v[16:17], v[104:105], v[224:225] neg_lo:[1,0,0] neg_hi:[1,0,0]
  v_pk_fma_f32 v[226:227], v[18:19], v[104:105], v[226:227] neg_lo:[1,0,0] neg_hi:[1,0,0]
  buffer_load_dwordx4 v13, s[56:59], s78 offen offset:1024 lds
  v_pk_fma_f32 v[228:229], v[20:21], v[104:105], v[228:229] neg_lo:[1,0,0] neg_hi:[1,0,0]
  v_pk_fma_f32 v[230:231], v[22:23], v[104:105], v[230:231] neg_lo:[1,0,0] neg_hi:[1,0,0]
  v_pk_fma_f32 v[232:233], v[24:25], v[104:105], v[232:233] neg_lo:[1,0,0] neg_hi:[1,0,0]
  v_pk_fma_f32 v[234:235], v[26:27], v[104:105], v[234:235] neg_lo:[1,0,0] neg_hi:[1,0,0]
  v_pk_fma_f32 v[236:237], v[28:29], v[104:105], v[236:237] neg_lo:[1,0,0] neg_hi:[1,0,0]
  v_pk_fma_f32 v[238:239], v[30:31], v[104:105], v[238:239] neg_lo:[1,0,0] neg_hi:[1,0,0]
  v_pk_mul_f32 v[224:225], v[224:225], v[88:89]
  v_pk_mul_f32 v[226:227], v[226:227], v[90:91]
  v_pk_mul_f32 v[228:229], v[228:229], v[92:93]
  v_pk_mul_f32 v[230:231], v[230:231], v[94:95]
  s_waitcnt lgkmcnt(4)
  s_add_u32 m0, s84, 4096
  s_add_u32 s78, s78, 57344
  buffer_load_dwordx4 v6, s[56:59], s78 offen offset:0 lds
  v_pk_mul_f32 v[232:233], v[232:233], v[96:97]
  v_pk_mul_f32 v[234:235], v[234:235], v[98:99]
  v_pk_mul_f32 v[236:237], v[236:237], v[100:101]
  v_pk_mul_f32 v[238:239], v[238:239], v[102:103]
  v_pk_fma_f32 v[240:241], v[16:17], v[108:109], v[240:241] neg_lo:[1,0,0] neg_hi:[1,0,0]
  v_pk_fma_f32 v[242:243], v[18:19], v[108:109], v[242:243] neg_lo:[1,0,0] neg_hi:[1,0,0]
  v_pk_fma_f32 v[244:245], v[20:21], v[108:109], v[244:245] neg_lo:[1,0,0] neg_hi:[1,0,0]
  v_pk_fma_f32 v[246:247], v[22:23], v[108:109], v[246:247] neg_lo:[1,0,0] neg_hi:[1,0,0]
  v_pk_fma_f32 v[248:249], v[24:25], v[108:109], v[248:249] neg_lo:[1,0,0] neg_hi:[1,0,0]
  v_pk_fma_f32 v[250:251], v[26:27], v[108:109], v[250:251] neg_lo:[1,0,0] neg_hi:[1,0,0]
  buffer_load_dwordx4 v13, s[56:59], s78 offen offset:1024 lds
  v_pk_fma_f32 v[252:253], v[28:29], v[108:109], v[252:253] neg_lo:[1,0,0] neg_hi:[1,0,0]
  v_pk_fma_f32 v[254:255], v[30:31], v[108:109], v[254:255] neg_lo:[1,0,0] neg_hi:[1,0,0]
  v_pk_mul_f32 v[240:241], v[240:241], v[88:89]
  v_pk_mul_f32 v[242:243], v[242:243], v[90:91]
  v_pk_mul_f32 v[244:245], v[244:245], v[92:93]
  v_pk_mul_f32 v[246:247], v[246:247], v[94:95]
  v_pk_mul_f32 v[248:249], v[248:249], v[96:97]
  v_pk_mul_f32 v[250:251], v[250:251], v[98:99]
  v_pk_mul_f32 v[252:253], v[252:253], v[100:101]
  v_pk_mul_f32 v[254:255], v[254:255], v[102:103]
  s_add_u32 m0, s84, 6144
  s_add_u32 s78, s78, 57344
  buffer_load_dwordx4 v6, s[56:59], s78 offen offset:0 lds
  s_waitcnt vmcnt(19)
  ds_read_b64_tr_b16 a[128:129], v2 offset:8192
  ds_read_b64_tr_b16 a[130:131], v2 offset:10240
  ds_read_b64_tr_b16 a[132:133], v3 offset:8192
  ds_read_b64_tr_b16 a[134:135], v3 offset:10240
  ds_read_b64_tr_b16 a[136:137], v4 offset:8192
  ds_read_b64_tr_b16 a[138:139], v4 offset:10240
  ds_read_b64_tr_b16 a[140:141], v5 offset:8192
  ds_read_b64_tr_b16 a[142:143], v5 offset:10240
  v_mov_b32 v16, v224
  v_mov_b32 v17, v240
  v_fma_f32 v18, v40, v16, v225
  v_fma_f32 v19, v40, v17, v241
  v_fma_f32 v18, -v41, v17, v18
  v_fma_f32 v17, v41, v16, v19
  v_fma_f32 v16, v40, v18, v226
  v_fma_f32 v19, v40, v17, v242
  v_fma_f32 v16, -v41, v17, v16
  v_fma_f32 v17, v41, v18, v19
  buffer_load_dwordx4 v13, s[56:59], s78 offen offset:1024 lds
  v_fma_f32 v18, v40, v16, v227
  v_fma_f32 v19, v40, v17, v243
  v_fma_f32 v18, -v41, v17, v18
  v_fma_f32 v17, v41, v16, v19
  v_fma_f32 v16, v40, v18, v228
  v_fma_f32 v19, v40, v17, v244
  v_fma_f32 v16, -v41, v17, v16
  v_fma_f32 v17, v41, v18, v19
  v_fma_f32 v18, v40, v16, v229
  v_fma_f32 v19, v40, v17, v245
  s_waitcnt lgkmcnt(0)
  s_add_u32 m0, s84, 8192
  s_add_u32 s78, s78, 57344
  buffer_load_dwordx4 v6, s[56:59], s78 offen offset:0 lds
  v_fma_f32 v18, -v41, v17, v18
  v_fma_f32 v17, v41, v16, v19
  v_fma_f32 v16, v40, v18, v230
  v_fma_f32 v19, v40, v17, v246
  v_fma_f32 v16, -v41, v17, v16
  v_fma_f32 v17, v41, v18, v19
  v_fma_f32 v18, v40, v16, v231
  v_fma_f32 v19, v40, v17, v247
  v_fma_f32 v18, -v41, v17, v18
  v_fma_f32 v17, v41, v16, v19
  buffer_load_dwordx4 v13, s[56:59], s78 offen offset:1024 lds
  v_fma_f32 v16, v40, v18, v232
  v_fma_f32 v19, v40, v17, v248
  v_fma_f32 v16, -v41, v17, v16
  v_fma_f32 v17, v41, v18, v19
  v_fma_f32 v18, v40, v16, v233
  v_fma_f32 v19, v40, v17, v249
  v_fma_f32 v18, -v41, v17, v18
  v_fma_f32 v17, v41, v16, v19
  v_fma_f32 v16, v40, v18, v234
  v_fma_f32 v19, v40, v17, v250
  s_add_u32 m0, s84, 10240
  s_add_u32 s78, s78, 57344
  buffer_load_dwordx4 v6, s[56:59], s78 offen offset:0 lds
  s_waitcnt vmcnt(19)
  ds_read_b64_tr_b16 a[144:145], v2 offset:12288
  ds_read_b64_tr_b16 a[146:147], v2 offset:14336
  ds_read_b64_tr_b16 a[148:149], v3 offset:12288
  ds_read_b64_tr_b16 a[150:151], v3 offset:14336
  ds_read_b64_tr_b16 a[152:153], v4 offset:12288
  ds_read_b64_tr_b16 a[154:155], v4 offset:14336
  ds_read_b64_tr_b16 a[156:157], v5 offset:12288
  ds_read_b64_tr_b16 a[158:159], v5 offset:14336
  v_fma_f32 v16, -v41, v17, v16
  v_fma_f32 v17, v41, v18, v19
  v_fma_f32 v18, v40, v16, v235
  v_fma_f32 v19, v40, v17, v251
  v_fma_f32 v18, -v41, v17, v18
  v_fma_f32 v17, v41, v16, v19
  v_fma_f32 v16, v40, v18, v236
  v_fma_f32 v19, v40, v17, v252
  v_fma_f32 v16, -v41, v17, v16
  v_fma_f32 v17, v41, v18, v19
  buffer_load_dwordx4 v13, s[56:59], s78 offen offset:1024 lds
  v_fma_f32 v18, v40, v16, v237
  v_fma_f32 v19, v40, v17, v253
  v_fma_f32 v18, -v41, v17, v18
  v_fma_f32 v17, v41, v16, v19
  v_fma_f32 v16, v40, v18, v238
  v_fma_f32 v19, v40, v17, v254
  v_fma_f32 v16, -v41, v17, v16
  v_fma_f32 v17, v41, v18, v19
  v_fma_f32 v18, v40, v16, v239
  v_fma_f32 v19, v40, v17, v255
  s_waitcnt lgkmcnt(0)
  s_add_u32 m0, s84, 12288
  s_add_u32 s78, s78, 57344
  buffer_load_dwordx4 v6, s[56:59], s78 offen offset:0 lds
  v_fma_f32 v18, -v41, v17, v18
  v_fma_f32 v17, v41, v16, v19
  v_mov_b32 v20, v18
  v_mov_b32 v21, v18
  s_nop 1
  v_permlane16_swap_b32 v20, v21
  v_mov_b32 v22, v20
  v_mov_b32 v23, v21
  s_nop 0
  v_permlane32_swap_b32 v20, v22
  v_permlane32_swap_b32 v21, v23
  v_mov_b32 v24, v17
  buffer_load_dwordx4 v13, s[56:59], s78 offen offset:1024 lds
  v_mov_b32 v25, v17
  s_nop 1
  v_permlane16_swap_b32 v24, v25
  v_mov_b32 v26, v24
  v_mov_b32 v27, v25
  s_nop 0
  v_permlane32_swap_b32 v24, v26
  v_permlane32_swap_b32 v25, v27
  v_fma_f32 v28, v52, v20, v21
  v_fma_f32 v29, v52, v24, v25
  v_fma_f32 v28, -v53, v24, v28
  v_fma_f32 v25, v53, v20, v29
  s_add_u32 m0, s84, 14336
  s_add_u32 s78, s78, 57344
  buffer_load_dwordx4 v6, s[56:59], s78 offen offset:0 lds
  s_waitcnt vmcnt(19)
  ds_read_b64_tr_b16 a[160:161], v2 offset:16384
  ds_read_b64_tr_b16 a[162:163], v2 offset:18432
  ds_read_b64_tr_b16 a[164:165], v3 offset:16384
  ds_read_b64_tr_b16 a[166:167], v3 offset:18432
  ds_read_b64_tr_b16 a[168:169], v4 offset:16384
  ds_read_b64_tr_b16 a[170:171], v4 offset:18432
  ds_read_b64_tr_b16 a[172:173], v5 offset:16384
  ds_read_b64_tr_b16 a[174:175], v5 offset:18432
  v_mov_b32 v21, v28
  v_fma_f32 v28, v52, v21, v22
  v_fma_f32 v29, v52, v25, v26
  v_fma_f32 v28, -v53, v25, v28
  v_fma_f32 v26, v53, v21, v29
  v_mov_b32 v22, v28
  v_fma_f32 v28, v52, v22, v23
  v_fma_f32 v29, v52, v26, v27
  v_fma_f32 v28, -v53, v26, v28
  v_fma_f32 v27, v53, v22, v29
  buffer_load_dwordx4 v13, s[56:59], s78 offen offset:1024 lds
  v_mov_b32 v23, v28
  v_mov_b32 v44, 0
  v_mov_b32 v45, 0
  s_mov_b32 exec_lo, 0xffff0000
  s_mov_b32 exec_hi, -1
  v_mov_b32 v44, v20
  v_mov_b32 v45, v24
  s_mov_b32 exec_lo, 0
  s_mov_b32 exec_hi, -1
  v_mov_b32 v44, v21
  v_mov_b32 v45, v25
  s_mov_b32 exec_lo, 0
  s_mov_b32 exec_hi, 0xffff0000
  v_mov_b32 v44, v22
  v_mov_b32 v45, v26
  s_mov_b64 exec, -1
  v_mov_b32 v10, v23
  s_waitcnt vmcnt(16)
  ds_read_b64_tr_b16 a[176:177], v2 offset:20480
  ds_read_b64_tr_b16 a[178:179], v2 offset:22528
  ds_read_b64_tr_b16 a[180:181], v3 offset:20480
  ds_read_b64_tr_b16 a[182:183], v3 offset:22528
  ds_read_b64_tr_b16 a[184:185], v4 offset:20480
  ds_read_b64_tr_b16 a[186:187], v4 offset:22528
  ds_read_b64_tr_b16 a[188:189], v5 offset:20480
  ds_read_b64_tr_b16 a[190:191], v5 offset:22528
  v_mov_b32 v11, v27
  v_lshlrev_b32 v8, 3, v0
  s_lshl_b32 s79, s68, 5
  s_add_u32 s79, s79, s67
  s_lshl_b32 s79, s79, 9
  s_lshl_b32 s80, s64, 7
  s_add_u32 s79, s79, s80
  s_add_u32 s79, s79, 1851392
  s_mov_b32 exec_lo, 0xffff
  s_mov_b32 exec_hi, 0
  buffer_store_dwordx2 v[10:11], v8, s[44:47], s79 offen sc1
  s_mov_b64 exec, -1
  v_cmp_gt_u32 vcc, 64, v34
  s_cbranch_vccz L_e0d_10
  s_mov_b32 s83, 0x40000
L_e0_9:
  global_load_dword v34, v35, s[34:35] sc1
  s_waitcnt vmcnt(0)
  v_cmp_gt_u32 vcc, 64, v34
  s_cbranch_vccz L_e0d_10
  s_sleep 4
  s_sub_u32 s83, s83, 1
  s_cbranch_scc0 L_e0_9
L_e0d_10:
  s_cmp_eq_u32 s71, 0
  s_cbranch_scc1 L_nog1_11
  v_lshrrev_b32 v8, 4, v0
  v_lshlrev_b32 v8, 3, v8
  s_lshl_b32 s79, s70, 7
  s_lshl_b32 s80, s65, 6
  s_add_u32 s79, s79, s80
  v_add_u32 v8, s79, v8
  global_load_dwordx2 v[32:33], v8, s[26:27]
  global_load_dwordx2 v[34:35], v8, s[26:27] offset:32
  s_mul_i32 s22, s69, 262144
  s_lshl_b32 s79, s64, 16
  s_add_u32 s22, s22, s79
  s_lshl_b32 s79, s66, 11
  s_xor_b32 s80, s79, 2048
  s_add_u32 s23, s22, s80
  s_add_u32 s22, s22, s79
  s_mov_b32 s76, s22
  s_mov_b32 s77, s23
  buffer_load_dwordx4 v[120:123], v1, s[44:47], s76 offen offset:0 sc1
  buffer_load_dwordx4 v[124:127], v1, s[44:47], s76 offen offset:1024 sc1
  s_add_u32 s76, s76, 4096
  buffer_load_dwordx4 v[128:131], v1, s[44:47], s77 offen offset:0 sc1
  buffer_load_dwordx4 v[132:135], v1, s[44:47], s77 offen offset:1024 sc1
  s_add_u32 s77, s77, 4096
  buffer_load_dwordx4 v[136:139], v1, s[44:47], s76 offen offset:0 sc1
  buffer_load_dwordx4 v[140:143], v1, s[44:47], s76 offen offset:1024 sc1
  s_add_u32 s76, s76, 4096
  buffer_load_dwordx4 v[144:147], v1, s[44:47], s77 offen offset:0 sc1
  buffer_load_dwordx4 v[148:151], v1, s[44:47], s77 offen offset:1024 sc1
  s_add_u32 s77, s77, 4096
  buffer_load_dwordx4 v[152:155], v1, s[44:47], s76 offen offset:0 sc1
  buffer_load_dwordx4 v[156:159], v1, s[44:47], s76 offen offset:1024 sc1
  s_add_u32 s76, s76, 4096
  buffer_load_dwordx4 v[160:163], v1, s[44:47], s77 offen offset:0 sc1
  buffer_load_dwordx4 v[164:167], v1, s[44:47], s77 offen offset:1024 sc1
  s_add_u32 s77, s77, 4096
  buffer_load_dwordx4 v[168:171], v1, s[44:47], s76 offen offset:0 sc1
  buffer_load_dwordx4 v[172:175], v1, s[44:47], s76 offen offset:1024 sc1
  s_add_u32 s76, s76, 4096
  buffer_load_dwordx4 v[176:179], v1, s[44:47], s77 offen offset:0 sc1
  buffer_load_dwordx4 v[180:183], v1, s[44:47], s77 offen offset:1024 sc1
  s_add_u32 s77, s77, 4096
  buffer_load_dwordx4 v[184:187], v1, s[44:47], s76 offen offset:0 sc1
  buffer_load_dwordx4 v[188:191], v1, s[44:47], s76 offen offset:1024 sc1
  s_add_u32 s76, s76, 4096
  buffer_load_dwordx4 v[192:195], v1, s[44:47], s77 offen offset:0 sc1
  buffer_load_dwordx4 v[196:199], v1, s[44:47], s77 offen offset:1024 sc1
  s_add_u32 s77, s77, 4096
  buffer_load_dwordx4 v[200:203], v1, s[44:47], s76 offen offset:0 sc1
  buffer_load_dwordx4 v[204:207], v1, s[44:47], s76 offen offset:1024 sc1
  s_add_u32 s76, s76, 4096
  buffer_load_dwordx4 v[208:211], v1, s[44:47], s77 offen offset:0 sc1
  buffer_load_dwordx4 v[212:215], v1, s[44:47], s77 offen offset:1024 sc1
  s_add_u32 s77, s77, 4096
  s_waitcnt vmcnt(39)
  ds_read_b64_tr_b16 a[192:193], v2 offset:0
  ds_read_b64_tr_b16 a[194:195], v2 offset:2048
  ds_read_b64_tr_b16 a[196:197], v3 offset:0
  ds_read_b64_tr_b16 a[198:199], v3 offset:2048
  ds_read_b64_tr_b16 a[200:201], v4 offset:0
  ds_read_b64_tr_b16 a[202:203], v4 offset:2048
  ds_read_b64_tr_b16 a[204:205], v5 offset:0
  ds_read_b64_tr_b16 a[206:207], v5 offset:2048
  s_waitcnt vmcnt(35)
  ds_read_b64_tr_b16 a[208:209], v2 offset:4096
  ds_read_b64_tr_b16 a[210:211], v2 offset:6144
  ds_read_b64_tr_b16 a[212:213], v3 offset:4096
  ds_read_b64_tr_b16 a[214:215], v3 offset:6144
  ds_read_b64_tr_b16 a[216:217], v4 offset:4096
  ds_read_b64_tr_b16 a[218:219], v4 offset:6144
  ds_read_b64_tr_b16 a[220:221], v5 offset:4096
  ds_read_b64_tr_b16 a[222:223], v5 offset:6144
  s_waitcnt vmcnt(31)
  ds_read_b64_tr_b16 a[224:225], v2 offset:8192
  ds_read_b64_tr_b16 a[226:227], v2 offset:10240
  ds_read_b64_tr_b16 a[228:229], v3 offset:8192
  ds_read_b64_tr_b16 a[230:231], v3 offset:10240
  ds_read_b64_tr_b16 a[232:233], v4 offset:8192
  ds_read_b64_tr_b16 a[234:235], v4 offset:10240
  ds_read_b64_tr_b16 a[236:237], v5 offset:8192
  ds_read_b64_tr_b16 a[238:239], v5 offset:10240
  s_waitcnt vmcnt(27)
  ds_read_b64_tr_b16 a[240:241], v2 offset:12288
  ds_read_b64_tr_b16 a[242:243], v2 offset:14336
  ds_read_b64_tr_b16 a[244:245], v3 offset:12288
  ds_read_b64_tr_b16 a[246:247], v3 offset:14336
  ds_read_b64_tr_b16 a[248:249], v4 offset:12288
  ds_read_b64_tr_b16 a[250:251], v4 offset:14336
  ds_read_b64_tr_b16 a[252:253], v5 offset:12288
  ds_read_b64_tr_b16 a[254:255], v5 offset:14336
  s_waitcnt lgkmcnt(0)
  s_mov_b32 s56, s28
  s_and_b32 s57, s29, 0xffff
  s_mov_b32 s58, 7340032
  s_mov_b32 s59, 0x20000
  v_lshrrev_b32 v7, 3, v0
  v_and_b32 v8, 7, v0
  v_and_b32 v9, 6, v7
  v_xor_b32 v8, v8, v9
  v_lshlrev_b32 v8, 4, v8
  v_mul_u32_u24 v7, 4096, v7
  v_add_u32 v6, v7, v8
  v_add_u32 v13, 31744, v6
  v_lshrrev_b32 v7, 2, v0
  v_and_b32 v8, 6, v7
  v_bfe_u32 v9, v0, 1, 1
  v_xor_b32 v8, v8, v9
  v_lshlrev_b32 v8, 4, v8
  v_lshlrev_b32 v7, 7, v7
  v_add_u32 v7, v7, v8
  v_and_b32 v9, 1, v0
  v_lshlrev_b32 v9, 3, v9
  v_add_u32 v7, v7, v9
  s_lshl_b32 s79, s66, 6
  v_xor_b32 v7, s79, v7
  v_add_u32 v2, s84, v7
  v_xor_b32 v3, 32, v2
  v_xor_b32 v4, 64, v2
  v_xor_b32 v5, 96, v2
  s_mul_i32 s96, s64, 1835008
  s_lshl_b32 s79, s67, 7
  s_add_u32 s96, s96, s79
  s_mov_b32 s78, s96
  s_waitcnt vmcnt(23)
  v_mfma_f32_16x16x32_bf16 v[56:59], a[0:3], v[120:123], 0
  v_mfma_f32_16x16x32_bf16 v[72:75], a[4:7], v[120:123], 0
  v_mfma_f32_16x16x32_bf16 v[88:91], a[8:11], v[120:123], 0
  v_mfma_f32_16x16x32_bf16 v[104:107], a[12:15], v[120:123], 0
  buffer_load_dwordx4 v[120:123], v1, s[44:47], s76 offen offset:0 sc1
  s_waitcnt vmcnt(23)
  v_mfma_f32_16x16x32_bf16 v[60:63], a[0:3], v[124:127], 0
  v_mfma_f32_16x16x32_bf16 v[76:79], a[4:7], v[124:127], 0
  v_mfma_f32_16x16x32_bf16 v[92:95], a[8:11], v[124:127], 0
  v_mfma_f32_16x16x32_bf16 v[108:111], a[12:15], v[124:127], 0
  buffer_load_dwordx4 v[124:127], v1, s[44:47], s76 offen offset:1024 sc1
  s_add_u32 s76, s76, 4096
  s_waitcnt vmcnt(23)
  v_mfma_f32_16x16x32_bf16 v[64:67], a[0:3], v[128:131], 0
  v_mfma_f32_16x16x32_bf16 v[80:83], a[4:7], v[128:131], 0
  v_mfma_f32_16x16x32_bf16 v[96:99], a[8:11], v[128:131], 0
  v_mfma_f32_16x16x32_bf16 v[112:115], a[12:15], v[128:131], 0
  buffer_load_dwordx4 v[128:131], v1, s[44:47], s77 offen offset:0 sc1
  s_waitcnt vmcnt(23)
  v_mfma_f32_16x16x32_bf16 v[68:71], a[0:3], v[132:135], 0
  v_mfma_f32_16x16x32_bf16 v[84:87], a[4:7], v[132:135], 0
  v_mfma_f32_16x16x32_bf16 v[100:103], a[8:11], v[132:135], 0
  v_mfma_f32_16x16x32_bf16 v[116:119], a[12:15], v[132:135], 0
  buffer_load_dwordx4 v[132:135], v1, s[44:47], s77 offen offset:1024 sc1
  s_add_u32 s77, s77, 4096
  s_waitcnt vmcnt(23)
  v_mfma_f32_16x16x32_bf16 v[56:59], a[16:19], v[136:139], v[56:59]
  v_mfma_f32_16x16x32_bf16 v[72:75], a[20:23], v[136:139], v[72:75]
  v_mfma_f32_16x16x32_bf16 v[88:91], a[24:27], v[136:139], v[88:91]
  v_mfma_f32_16x16x32_bf16 v[104:107], a[28:31], v[136:139], v[104:107]
  buffer_load_dwordx4 v[136:139], v1, s[44:47], s76 offen offset:0 sc1
  s_waitcnt vmcnt(23)
  v_mfma_f32_16x16x32_bf16 v[60:63], a[16:19], v[140:143], v[60:63]
  v_mfma_f32_16x16x32_bf16 v[76:79], a[20:23], v[140:143], v[76:79]
  v_mfma_f32_16x16x32_bf16 v[92:95], a[24:27], v[140:143], v[92:95]
  v_mfma_f32_16x16x32_bf16 v[108:111], a[28:31], v[140:143], v[108:111]
  buffer_load_dwordx4 v[140:143], v1, s[44:47], s76 offen offset:1024 sc1
  s_add_u32 s76, s76, 4096
  s_waitcnt vmcnt(23)
  v_mfma_f32_16x16x32_bf16 v[64:67], a[16:19], v[144:147], v[64:67]
  v_mfma_f32_16x16x32_bf16 v[80:83], a[20:23], v[144:147], v[80:83]
  v_mfma_f32_16x16x32_bf16 v[96:99], a[24:27], v[144:147], v[96:99]
  v_mfma_f32_16x16x32_bf16 v[112:115], a[28:31], v[144:147], v[112:115]
  buffer_load_dwordx4 v[144:147], v1, s[44:47], s77 offen offset:0 sc1
  s_waitcnt vmcnt(23)
  v_mfma_f32_16x16x32_bf16 v[68:71], a[16:19], v[148:151], v[68:71]
  v_mfma_f32_16x16x32_bf16 v[84:87], a[20:23], v[148:151], v[84:87]
  v_mfma_f32_16x16x32_bf16 v[100:103], a[24:27], v[148:151], v[100:103]
  v_mfma_f32_16x16x32_bf16 v[116:119], a[28:31], v[148:151], v[116:119]
  buffer_load_dwordx4 v[148:151], v1, s[44:47], s77 offen offset:1024 sc1
  s_add_u32 s77, s77, 4096
  s_waitcnt vmcnt(23)
  v_mfma_f32_16x16x32_bf16 v[56:59], a[32:35], v[152:155], v[56:59]
  v_mfma_f32_16x16x32_bf16 v[72:75], a[36:39], v[152:155], v[72:75]
  v_mfma_f32_16x16x32_bf16 v[88:91], a[40:43], v[152:155], v[88:91]
  v_mfma_f32_16x16x32_bf16 v[104:107], a[44:47], v[152:155], v[104:107]
  buffer_load_dwordx4 v[152:155], v1, s[44:47], s76 offen offset:0 sc1
  s_waitcnt vmcnt(23)
  v_mfma_f32_16x16x32_bf16 v[60:63], a[32:35], v[156:159], v[60:63]
  v_mfma_f32_16x16x32_bf16 v[76:79], a[36:39], v[156:159], v[76:79]
  v_mfma_f32_16x16x32_bf16 v[92:95], a[40:43], v[156:159], v[92:95]
  v_mfma_f32_16x16x32_bf16 v[108:111], a[44:47], v[156:159], v[108:111]
  buffer_load_dwordx4 v[156:159], v1, s[44:47], s76 offen offset:1024 sc1
  s_add_u32 s76, s76, 4096
  s_waitcnt vmcnt(23)
  v_mfma_f32_16x16x32_bf16 v[64:67], a[32:35], v[160:163], v[64:67]
  v_mfma_f32_16x16x32_bf16 v[80:83], a[36:39], v[160:163], v[80:83]
  v_mfma_f32_16x16x32_bf16 v[96:99], a[40:43], v[160:163], v[96:99]
  v_mfma_f32_16x16x32_bf16 v[112:115], a[44:47], v[160:163], v[112:115]
  buffer_load_dwordx4 v[160:163], v1, s[44:47], s77 offen offset:0 sc1
  s_waitcnt vmcnt(23)
  v_mfma_f32_16x16x32_bf16 v[68:71], a[32:35], v[164:167], v[68:71]
  v_mfma_f32_16x16x32_bf16 v[84:87], a[36:39], v[164:167], v[84:87]
  v_mfma_f32_16x16x32_bf16 v[100:103], a[40:43], v[164:167], v[100:103]
  v_mfma_f32_16x16x32_bf16 v[116:119], a[44:47], v[164:167], v[116:119]
  buffer_load_dwordx4 v[164:167], v1, s[44:47], s77 offen offset:1024 sc1
  s_add_u32 s77, s77, 4096
  s_waitcnt vmcnt(23)
  v_mfma_f32_16x16x32_bf16 v[56:59], a[48:51], v[168:171], v[56:59]
  v_mfma_f32_16x16x32_bf16 v[72:75], a[52:55], v[168:171], v[72:75]
  v_mfma_f32_16x16x32_bf16 v[88:91], a[56:59], v[168:171], v[88:91]
  v_mfma_f32_16x16x32_bf16 v[104:107], a[60:63], v[168:171], v[104:107]
  buffer_load_dwordx4 v[168:171], v1, s[44:47], s76 offen offset:0 sc1
  s_waitcnt vmcnt(23)
  v_mfma_f32_16x16x32_bf16 v[60:63], a[48:51], v[172:175], v[60:63]
  v_mfma_f32_16x16x32_bf16 v[76:79], a[52:55], v[172:175], v[76:79]
  v_mfma_f32_16x16x32_bf16 v[92:95], a[56:59], v[172:175], v[92:95]
  v_mfma_f32_16x16x32_bf16 v[108:111], a[60:63], v[172:175], v[108:111]
  buffer_load_dwordx4 v[172:175], v1, s[44:47], s76 offen offset:1024 sc1
  s_add_u32 s76, s76, 4096
  s_waitcnt vmcnt(23)
  v_mfma_f32_16x16x32_bf16 v[64:67], a[48:51], v[176:179], v[64:67]
  v_mfma_f32_16x16x32_bf16 v[80:83], a[52:55], v[176:179], v[80:83]
  v_mfma_f32_16x16x32_bf16 v[96:99], a[56:59], v[176:179], v[96:99]
  v_mfma_f32_16x16x32_bf16 v[112:115], a[60:63], v[176:179], v[112:115]
  buffer_load_dwordx4 v[176:179], v1, s[44:47], s77 offen offset:0 sc1
  s_waitcnt vmcnt(23)
  v_mfma_f32_16x16x32_bf16 v[68:71], a[48:51], v[180:183], v[68:71]
  v_mfma_f32_16x16x32_bf16 v[84:87], a[52:55], v[180:183], v[84:87]
  v_mfma_f32_16x16x32_bf16 v[100:103], a[56:59], v[180:183], v[100:103]
  v_mfma_f32_16x16x32_bf16 v[116:119], a[60:63], v[180:183], v[116:119]
  buffer_load_dwordx4 v[180:183], v1, s[44:47], s77 offen offset:1024 sc1
  s_add_u32 s77, s77, 4096
  s_waitcnt vmcnt(23)
  v_mfma_f32_16x16x32_bf16 v[56:59], a[64:67], v[184:187], v[56:59]
  v_mfma_f32_16x16x32_bf16 v[72:75], a[68:71], v[184:187], v[72:75]
  v_mfma_f32_16x16x32_bf16 v[88:91], a[72:75], v[184:187], v[88:91]
  v_mfma_f32_16x16x32_bf16 v[104:107], a[76:79], v[184:187], v[104:107]
  buffer_load_dwordx4 v[184:187], v1, s[44:47], s76 offen offset:0 sc1
  s_waitcnt vmcnt(23)
  v_mfma_f32_16x16x32_bf16 v[60:63], a[64:67], v[188:191], v[60:63]
  v_mfma_f32_16x16x32_bf16 v[76:79], a[68:71], v[188:191], v[76:79]
  v_mfma_f32_16x16x32_bf16 v[92:95], a[72:75], v[188:191], v[92:95]
  v_mfma_f32_16x16x32_bf16 v[108:111], a[76:79], v[188:191], v[108:111]
  buffer_load_dwordx4 v[188:191], v1, s[44:47], s76 offen offset:1024 sc1
  s_add_u32 s76, s76, 4096
  s_waitcnt vmcnt(23)
  v_mfma_f32_16x16x32_bf16 v[64:67], a[64:67], v[192:195], v[64:67]
  v_mfma_f32_16x16x32_bf16 v[80:83], a[68:71], v[192:195], v[80:83]
  v_mfma_f32_16x16x32_bf16 v[96:99], a[72:75], v[192:195], v[96:99]
  v_mfma_f32_16x16x32_bf16 v[112:115], a[76:79], v[192:195], v[112:115]
  buffer_load_dwordx4 v[192:195], v1, s[44:47], s77 offen offset:0 sc1
  s_waitcnt vmcnt(23)
  v_mfma_f32_16x16x32_bf16 v[68:71], a[64:67], v[196:199], v[68:71]
  v_mfma_f32_16x16x32_bf16 v[84:87], a[68:71], v[196:199], v[84:87]
  v_mfma_f32_16x16x32_bf16 v[100:103], a[72:75], v[196:199], v[100:103]
  v_mfma_f32_16x16x32_bf16 v[116:119], a[76:79], v[196:199], v[116:119]
  buffer_load_dwordx4 v[196:199], v1, s[44:47], s77 offen offset:1024 sc1
  s_add_u32 s77, s77, 4096
  s_waitcnt vmcnt(23)
  v_mfma_f32_16x16x32_bf16 v[56:59], a[80:83], v[200:203], v[56:59]
  v_mfma_f32_16x16x32_bf16 v[72:75], a[84:87], v[200:203], v[72:75]
  v_mfma_f32_16x16x32_bf16 v[88:91], a[88:91], v[200:203], v[88:91]
  v_mfma_f32_16x16x32_bf16 v[104:107], a[92:95], v[200:203], v[104:107]
  buffer_load_dwordx4 v[200:203], v1, s[44:47], s76 offen offset:0 sc1
  s_waitcnt vmcnt(23)
  v_mfma_f32_16x16x32_bf16 v[60:63], a[80:83], v[204:207], v[60:63]
  v_mfma_f32_16x16x32_bf16 v[76:79], a[84:87], v[204:207], v[76:79]
  v_mfma_f32_16x16x32_bf16 v[92:95], a[88:91], v[204:207], v[92:95]
  v_mfma_f32_16x16x32_bf16 v[108:111], a[92:95], v[204:207], v[108:111]
  buffer_load_dwordx4 v[204:207], v1, s[44:47], s76 offen offset:1024 sc1
  s_add_u32 s76, s76, 4096
  s_waitcnt vmcnt(23)
  v_mfma_f32_16x16x32_bf16 v[64:67], a[80:83], v[208:211], v[64:67]
  v_mfma_f32_16x16x32_bf16 v[80:83], a[84:87], v[208:211], v[80:83]
  v_mfma_f32_16x16x32_bf16 v[96:99], a[88:91], v[208:211], v[96:99]
  v_mfma_f32_16x16x32_bf16 v[112:115], a[92:95], v[208:211], v[112:115]
  buffer_load_dwordx4 v[208:211], v1, s[44:47], s77 offen offset:0 sc1
  s_waitcnt vmcnt(23)
  v_mfma_f32_16x16x32_bf16 v[68:71], a[80:83], v[212:215], v[68:71]
  v_mfma_f32_16x16x32_bf16 v[84:87], a[84:87], v[212:215], v[84:87]
  v_mfma_f32_16x16x32_bf16 v[100:103], a[88:91], v[212:215], v[100:103]
  v_mfma_f32_16x16x32_bf16 v[116:119], a[92:95], v[212:215], v[116:119]
  buffer_load_dwordx4 v[212:215], v1, s[44:47], s77 offen offset:1024 sc1
  s_add_u32 s77, s77, 4096
  s_waitcnt vmcnt(23)
  v_mfma_f32_16x16x32_bf16 v[56:59], a[96:99], v[120:123], v[56:59]
  v_mfma_f32_16x16x32_bf16 v[72:75], a[100:103], v[120:123], v[72:75]
  v_mfma_f32_16x16x32_bf16 v[88:91], a[104:107], v[120:123], v[88:91]
  v_mfma_f32_16x16x32_bf16 v[104:107], a[108:111], v[120:123], v[104:107]
  buffer_load_dwordx4 v[120:123], v1, s[44:47], s76 offen offset:0 sc1
  s_waitcnt vmcnt(23)
  v_mfma_f32_16x16x32_bf16 v[60:63], a[96:99], v[124:127], v[60:63]
  v_mfma_f32_16x16x32_bf16 v[76:79], a[100:103], v[124:127], v[76:79]
  v_mfma_f32_16x16x32_bf16 v[92:95], a[104:107], v[124:127], v[92:95]
  v_mfma_f32_16x16x32_bf16 v[108:111], a[108:111], v[124:127], v[108:111]
  buffer_load_dwordx4 v[124:127], v1, s[44:47], s76 offen offset:1024 sc1
  s_add_u32 s76, s76, 4096
  s_waitcnt vmcnt(23)
  v_mfma_f32_16x16x32_bf16 v[64:67], a[96:99], v[128:131], v[64:67]
  v_mfma_f32_16x16x32_bf16 v[80:83], a[100:103], v[128:131], v[80:83]
  v_mfma_f32_16x16x32_bf16 v[96:99], a[104:107], v[128:131], v[96:99]
  v_mfma_f32_16x16x32_bf16 v[112:115], a[108:111], v[128:131], v[112:115]
  buffer_load_dwordx4 v[128:131], v1, s[44:47], s77 offen offset:0 sc1
  s_waitcnt vmcnt(23)
  v_mfma_f32_16x16x32_bf16 v[68:71], a[96:99], v[132:135], v[68:71]
  v_mfma_f32_16x16x32_bf16 v[84:87], a[100:103], v[132:135], v[84:87]
  v_mfma_f32_16x16x32_bf16 v[100:103], a[104:107], v[132:135], v[100:103]
  v_mfma_f32_16x16x32_bf16 v[116:119], a[108:111], v[132:135], v[116:119]
  buffer_load_dwordx4 v[132:135], v1, s[44:47], s77 offen offset:1024 sc1
  s_add_u32 s77, s77, 4096
  s_waitcnt vmcnt(23)
  v_mfma_f32_16x16x32_bf16 v[56:59], a[112:115], v[136:139], v[56:59]
  v_mfma_f32_16x16x32_bf16 v[72:75], a[116:119], v[136:139], v[72:75]
  v_mfma_f32_16x16x32_bf16 v[88:91], a[120:123], v[136:139], v[88:91]
  v_mfma_f32_16x16x32_bf16 v[104:107], a[124:127], v[136:139], v[104:107]
  buffer_load_dwordx4 v[136:139], v1, s[44:47], s76 offen offset:0 sc1
  s_waitcnt vmcnt(23)
  v_mfma_f32_16x16x32_bf16 v[60:63], a[112:115], v[140:143], v[60:63]
  v_mfma_f32_16x16x32_bf16 v[76:79], a[116:119], v[140:143], v[76:79]
  v_mfma_f32_16x16x32_bf16 v[92:95], a[120:123], v[140:143], v[92:95]
  v_mfma_f32_16x16x32_bf16 v[108:111], a[124:127], v[140:143], v[108:111]
  buffer_load_dwordx4 v[140:143], v1, s[44:47], s76 offen offset:1024 sc1
  s_add_u32 s76, s76, 4096
  s_waitcnt vmcnt(23)
  v_mfma_f32_16x16x32_bf16 v[64:67], a[112:115], v[144:147], v[64:67]
  v_mfma_f32_16x16x32_bf16 v[80:83], a[116:119], v[144:147], v[80:83]
  v_mfma_f32_16x16x32_bf16 v[96:99], a[120:123], v[144:147], v[96:99]
  v_mfma_f32_16x16x32_bf16 v[112:115], a[124:127], v[144:147], v[112:115]
  buffer_load_dwordx4 v[144:147], v1, s[44:47], s77 offen offset:0 sc1
  s_waitcnt vmcnt(23)
  v_mfma_f32_16x16x32_bf16 v[68:71], a[112:115], v[148:151], v[68:71]
  v_mfma_f32_16x16x32_bf16 v[84:87], a[116:119], v[148:151], v[84:87]
  v_mfma_f32_16x16x32_bf16 v[100:103], a[120:123], v[148:151], v[100:103]
  v_mfma_f32_16x16x32_bf16 v[116:119], a[124:127], v[148:151], v[116:119]
  buffer_load_dwordx4 v[148:151], v1, s[44:47], s77 offen offset:1024 sc1
  s_add_u32 s77, s77, 4096
  s_waitcnt vmcnt(23)
  v_mfma_f32_16x16x32_bf16 v[56:59], a[128:131], v[152:155], v[56:59]
  v_mfma_f32_16x16x32_bf16 v[72:75], a[132:135], v[152:155], v[72:75]
  v_mfma_f32_16x16x32_bf16 v[88:91], a[136:139], v[152:155], v[88:91]
  v_mfma_f32_16x16x32_bf16 v[104:107], a[140:143], v[152:155], v[104:107]
  buffer_load_dwordx4 v[152:155], v1, s[44:47], s76 offen offset:0 sc1
  s_waitcnt vmcnt(23)
  v_mfma_f32_16x16x32_bf16 v[60:63], a[128:131], v[156:159], v[60:63]
  v_mfma_f32_16x16x32_bf16 v[76:79], a[132:135], v[156:159], v[76:79]
  v_mfma_f32_16x16x32_bf16 v[92:95], a[136:139], v[156:159], v[92:95]
  v_mfma_f32_16x16x32_bf16 v[108:111], a[140:143], v[156:159], v[108:111]
  buffer_load_dwordx4 v[156:159], v1, s[44:47], s76 offen offset:1024 sc1
  s_add_u32 s76, s76, 4096
  s_waitcnt vmcnt(23)
  v_mfma_f32_16x16x32_bf16 v[64:67], a[128:131], v[160:163], v[64:67]
  v_mfma_f32_16x16x32_bf16 v[80:83], a[132:135], v[160:163], v[80:83]
  v_mfma_f32_16x16x32_bf16 v[96:99], a[136:139], v[160:163], v[96:99]
  v_mfma_f32_16x16x32_bf16 v[112:115], a[140:143], v[160:163], v[112:115]
  buffer_load_dwordx4 v[160:163], v1, s[44:47], s77 offen offset:0 sc1
  s_waitcnt vmcnt(23)
  v_mfma_f32_16x16x32_bf16 v[68:71], a[128:131], v[164:167], v[68:71]
  v_mfma_f32_16x16x32_bf16 v[84:87], a[132:135], v[164:167], v[84:87]
  v_mfma_f32_16x16x32_bf16 v[100:103], a[136:139], v[164:167], v[100:103]
  v_mfma_f32_16x16x32_bf16 v[116:119], a[140:143], v[164:167], v[116:119]
  buffer_load_dwordx4 v[164:167], v1, s[44:47], s77 offen offset:1024 sc1
  s_add_u32 s77, s77, 4096
  s_waitcnt vmcnt(23)
  v_mfma_f32_16x16x32_bf16 v[56:59], a[144:147], v[168:171], v[56:59]
  v_mfma_f32_16x16x32_bf16 v[72:75], a[148:151], v[168:171], v[72:75]
  v_mfma_f32_16x16x32_bf16 v[88:91], a[152:155], v[168:171], v[88:91]
  v_mfma_f32_16x16x32_bf16 v[104:107], a[156:159], v[168:171], v[104:107]
  buffer_load_dwordx4 v[168:171], v1, s[44:47], s76 offen offset:0 sc1
  s_waitcnt vmcnt(23)
  v_mfma_f32_16x16x32_bf16 v[60:63], a[144:147], v[172:175], v[60:63]
  v_mfma_f32_16x16x32_bf16 v[76:79], a[148:151], v[172:175], v[76:79]
  v_mfma_f32_16x16x32_bf16 v[92:95], a[152:155], v[172:175], v[92:95]
  v_mfma_f32_16x16x32_bf16 v[108:111], a[156:159], v[172:175], v[108:111]
  buffer_load_dwordx4 v[172:175], v1, s[44:47], s76 offen offset:1024 sc1
  s_waitcnt vmcnt(23)
  v_mfma_f32_16x16x32_bf16 v[64:67], a[144:147], v[176:179], v[64:67]
  v_mfma_f32_16x16x32_bf16 v[80:83], a[148:151], v[176:179], v[80:83]
  v_mfma_f32_16x16x32_bf16 v[96:99], a[152:155], v[176:179], v[96:99]
  v_mfma_f32_16x16x32_bf16 v[112:115], a[156:159], v[176:179], v[112:115]
  buffer_load_dwordx4 v[176:179], v1, s[44:47], s77 offen offset:0 sc1
  s_waitcnt vmcnt(23)
  v_mfma_f32_16x16x32_bf16 v[68:71], a[144:147], v[180:183], v[68:71]
  v_mfma_f32_16x16x32_bf16 v[84:87], a[148:151], v[180:183], v[84:87]
  v_mfma_f32_16x16x32_bf16 v[100:103], a[152:155], v[180:183], v[100:103]
  v_mfma_f32_16x16x32_bf16 v[116:119], a[156:159], v[180:183], v[116:119]
  buffer_load_dwordx4 v[180:183], v1, s[44:47], s77 offen offset:1024 sc1
  s_waitcnt vmcnt(23)
  v_mfma_f32_16x16x32_bf16 v[56:59], a[160:163], v[184:187], v[56:59]
  v_mfma_f32_16x16x32_bf16 v[72:75], a[164:167], v[184:187], v[72:75]
  v_mfma_f32_16x16x32_bf16 v[88:91], a[168:171], v[184:187], v[88:91]
  v_mfma_f32_16x16x32_bf16 v[104:107], a[172:175], v[184:187], v[104:107]
  s_add_u32 m0, s84, 0
  s_nop 0
  buffer_load_dwordx4 v6, s[56:59], s78 offen offset:0 lds
  s_waitcnt vmcnt(23)
  v_mfma_f32_16x16x32_bf16 v[60:63], a[160:163], v[188:191], v[60:63]
  v_mfma_f32_16x16x32_bf16 v[76:79], a[164:167], v[188:191], v[76:79]
  v_mfma_f32_16x16x32_bf16 v[92:95], a[168:171], v[188:191], v[92:95]
  v_mfma_f32_16x16x32_bf16 v[108:111], a[172:175], v[188:191], v[108:111]
  buffer_load_dwordx4 v13, s[56:59], s78 offen offset:1024 lds
  s_waitcnt vmcnt(23)
  v_mfma_f32_16x16x32_bf16 v[64:67], a[160:163], v[192:195], v[64:67]
  v_mfma_f32_16x16x32_bf16 v[80:83], a[164:167], v[192:195], v[80:83]
  v_mfma_f32_16x16x32_bf16 v[96:99], a[168:171], v[192:195], v[96:99]
  v_mfma_f32_16x16x32_bf16 v[112:115], a[172:175], v[192:195], v[112:115]
  s_add_u32 m0, s84, 2048
  s_add_u32 s78, s78, 65536
  buffer_load_dwordx4 v6, s[56:59], s78 offen offset:0 lds
  s_waitcnt vmcnt(23)
  v_mfma_f32_16x16x32_bf16 v[68:71], a[160:163], v[196:199], v[68:71]
  v_mfma_f32_16x16x32_bf16 v[84:87], a[164:167], v[196:199], v[84:87]
  v_mfma_f32_16x16x32_bf16 v[100:103], a[168:171], v[196:199], v[100:103]
  v_mfma_f32_16x16x32_bf16 v[116:119], a[172:175], v[196:199], v[116:119]
  buffer_load_dwordx4 v13, s[56:59], s78 offen offset:1024 lds
  s_waitcnt vmcnt(23)
  v_mfma_f32_16x16x32_bf16 v[56:59], a[176:179], v[200:203], v[56:59]
  v_mfma_f32_16x16x32_bf16 v[72:75], a[180:183], v[200:203], v[72:75]
  v_mfma_f32_16x16x32_bf16 v[88:91], a[184:187], v[200:203], v[88:91]
  v_mfma_f32_16x16x32_bf16 v[104:107], a[188:191], v[200:203], v[104:107]
  s_add_u32 m0, s84, 4096
  s_add_u32 s78, s78, 65536
  buffer_load_dwordx4 v6, s[56:59], s78 offen offset:0 lds
  s_waitcnt vmcnt(23)
  v_mfma_f32_16x16x32_bf16 v[60:63], a[176:179], v[204:207], v[60:63]
  v_mfma_f32_16x16x32_bf16 v[76:79], a[180:183], v[204:207], v[76:79]
  v_mfma_f32_16x16x32_bf16 v[92:95], a[184:187], v[204:207], v[92:95]
  v_mfma_f32_16x16x32_bf16 v[108:111], a[188:191], v[204:207], v[108:111]
  buffer_load_dwordx4 v13, s[56:59], s78 offen offset:1024 lds
  s_waitcnt vmcnt(23)
  v_mfma_f32_16x16x32_bf16 v[64:67], a[176:179], v[208:211], v[64:67]
  v_mfma_f32_16x16x32_bf16 v[80:83], a[180:183], v[208:211], v[80:83]
  v_mfma_f32_16x16x32_bf16 v[96:99], a[184:187], v[208:211], v[96:99]
  v_mfma_f32_16x16x32_bf16 v[112:115], a[188:191], v[208:211], v[112:115]
  s_add_u32 m0, s84, 6144
  s_add_u32 s78, s78, 65536
  buffer_load_dwordx4 v6, s[56:59], s78 offen offset:0 lds
  s_waitcnt vmcnt(23)
  v_mfma_f32_16x16x32_bf16 v[68:71], a[176:179], v[212:215], v[68:71]
  v_mfma_f32_16x16x32_bf16 v[84:87], a[180:183], v[212:215], v[84:87]
  v_mfma_f32_16x16x32_bf16 v[100:103], a[184:187], v[212:215], v[100:103]
  v_mfma_f32_16x16x32_bf16 v[116:119], a[188:191], v[212:215], v[116:119]
  buffer_load_dwordx4 v13, s[56:59], s78 offen offset:1024 lds
  s_waitcnt vmcnt(23)
  v_mfma_f32_16x16x32_bf16 v[56:59], a[192:195], v[120:123], v[56:59]
  v_mfma_f32_16x16x32_bf16 v[72:75], a[196:199], v[120:123], v[72:75]
  v_mfma_f32_16x16x32_bf16 v[88:91], a[200:203], v[120:123], v[88:91]
  v_mfma_f32_16x16x32_bf16 v[104:107], a[204:207], v[120:123], v[104:107]
  s_add_u32 m0, s84, 8192
  s_add_u32 s78, s78, 65536
  buffer_load_dwordx4 v6, s[56:59], s78 offen offset:0 lds
  s_waitcnt vmcnt(23)
  v_mfma_f32_16x16x32_bf16 v[60:63], a[192:195], v[124:127], v[60:63]
  v_mfma_f32_16x16x32_bf16 v[76:79], a[196:199], v[124:127], v[76:79]
  v_mfma_f32_16x16x32_bf16 v[92:95], a[200:203], v[124:127], v[92:95]
  v_mfma_f32_16x16x32_bf16 v[108:111], a[204:207], v[124:127], v[108:111]
  buffer_load_dwordx4 v13, s[56:59], s78 offen offset:1024 lds
  s_waitcnt vmcnt(23)
  v_mfma_f32_16x16x32_bf16 v[64:67], a[192:195], v[128:131], v[64:67]
  v_mfma_f32_16x16x32_bf16 v[80:83], a[196:199], v[128:131], v[80:83]
  v_mfma_f32_16x16x32_bf16 v[96:99], a[200:203], v[128:131], v[96:99]
  v_mfma_f32_16x16x32_bf16 v[112:115], a[204:207], v[128:131], v[112:115]
  s_add_u32 m0, s84, 10240
  s_add_u32 s78, s78, 65536
  buffer_load_dwordx4 v6, s[56:59], s78 offen offset:0 lds
  s_waitcnt vmcnt(23)
  v_mfma_f32_16x16x32_bf16 v[68:71], a[192:195], v[132:135], v[68:71]
  v_mfma_f32_16x16x32_bf16 v[84:87], a[196:199], v[132:135], v[84:87]
  v_mfma_f32_16x16x32_bf16 v[100:103], a[200:203], v[132:135], v[100:103]
  v_mfma_f32_16x16x32_bf16 v[116:119], a[204:207], v[132:135], v[116:119]
  buffer_load_dwordx4 v13, s[56:59], s78 offen offset:1024 lds
  s_waitcnt vmcnt(23)
  v_mfma_f32_16x16x32_bf16 v[56:59], a[208:211], v[136:139], v[56:59]
  v_mfma_f32_16x16x32_bf16 v[72:75], a[212:215], v[136:139], v[72:75]
  v_mfma_f32_16x16x32_bf16 v[88:91], a[216:219], v[136:139], v[88:91]
  v_mfma_f32_16x16x32_bf16 v[104:107], a[220:223], v[136:139], v[104:107]
  s_add_u32 m0, s84, 12288
  s_add_u32 s78, s78, 65536
  buffer_load_dwordx4 v6, s[56:59], s78 offen offset:0 lds
  s_waitcnt vmcnt(23)
  v_mfma_f32_16x16x32_bf16 v[60:63], a[208:211], v[140:143], v[60:63]
  v_mfma_f32_16x16x32_bf16 v[76:79], a[212:215], v[140:143], v[76:79]
  v_mfma_f32_16x16x32_bf16 v[92:95], a[216:219], v[140:143], v[92:95]
  v_mfma_f32_16x16x32_bf16 v[108:111], a[220:223], v[140:143], v[108:111]
  buffer_load_dwordx4 v13, s[56:59], s78 offen offset:1024 lds
  s_waitcnt vmcnt(23)
  v_mfma_f32_16x16x32_bf16 v[64:67], a[208:211], v[144:147], v[64:67]
  v_mfma_f32_16x16x32_bf16 v[80:83], a[212:215], v[144:147], v[80:83]
  v_mfma_f32_16x16x32_bf16 v[96:99], a[216:219], v[144:147], v[96:99]
  v_mfma_f32_16x16x32_bf16 v[112:115], a[220:223], v[144:147], v[112:115]
  s_add_u32 m0, s84, 14336
  s_add_u32 s78, s78, 65536
  buffer_load_dwordx4 v6, s[56:59], s78 offen offset:0 lds
  s_waitcnt vmcnt(23)
  v_mfma_f32_16x16x32_bf16 v[68:71], a[208:211], v[148:151], v[68:71]
  v_mfma_f32_16x16x32_bf16 v[84:87], a[212:215], v[148:151], v[84:87]
  v_mfma_f32_16x16x32_bf16 v[100:103], a[216:219], v[148:151], v[100:103]
  v_mfma_f32_16x16x32_bf16 v[116:119], a[220:223], v[148:151], v[116:119]
  buffer_load_dwordx4 v13, s[56:59], s78 offen offset:1024 lds
  s_waitcnt vmcnt(23)
  v_mfma_f32_16x16x32_bf16 v[56:59], a[224:227], v[152:155], v[56:59]
  v_mfma_f32_16x16x32_bf16 v[72:75], a[228:231], v[152:155], v[72:75]
  v_mfma_f32_16x16x32_bf16 v[88:91], a[232:235], v[152:155], v[88:91]
  v_mfma_f32_16x16x32_bf16 v[104:107], a[236:239], v[152:155], v[104:107]
  s_add_u32 m0, s84, 16384
  s_add_u32 s78, s78, 65536
  buffer_load_dwordx4 v6, s[56:59], s78 offen offset:0 lds
  s_waitcnt vmcnt(23)
  v_mfma_f32_16x16x32_bf16 v[60:63], a[224:227], v[156:159], v[60:63]
  v_mfma_f32_16x16x32_bf16 v[76:79], a[228:231], v[156:159], v[76:79]
  v_mfma_f32_16x16x32_bf16 v[92:95], a[232:235], v[156:159], v[92:95]
  v_mfma_f32_16x16x32_bf16 v[108:111], a[236:239], v[156:159], v[108:111]
  buffer_load_dwordx4 v13, s[56:59], s78 offen offset:1024 lds
  s_waitcnt vmcnt(23)
  v_mfma_f32_16x16x32_bf16 v[64:67], a[224:227], v[160:163], v[64:67]
  v_mfma_f32_16x16x32_bf16 v[80:83], a[228:231], v[160:163], v[80:83]
  v_mfma_f32_16x16x32_bf16 v[96:99], a[232:235], v[160:163], v[96:99]
  v_mfma_f32_16x16x32_bf16 v[112:115], a[236:239], v[160:163], v[112:115]
  s_add_u32 m0, s84, 18432
  s_add_u32 s78, s78, 65536
  buffer_load_dwordx4 v6, s[56:59], s78 offen offset:0 lds
  s_waitcnt vmcnt(23)
  v_mfma_f32_16x16x32_bf16 v[68:71], a[224:227], v[164:167], v[68:71]
  v_mfma_f32_16x16x32_bf16 v[84:87], a[228:231], v[164:167], v[84:87]
  v_mfma_f32_16x16x32_bf16 v[100:103], a[232:235], v[164:167], v[100:103]
  v_mfma_f32_16x16x32_bf16 v[116:119], a[236:239], v[164:167], v[116:119]
  buffer_load_dwordx4 v13, s[56:59], s78 offen offset:1024 lds
  s_waitcnt vmcnt(23)
  v_mfma_f32_16x16x32_bf16 v[56:59], a[240:243], v[168:171], v[56:59]
  v_mfma_f32_16x16x32_bf16 v[72:75], a[244:247], v[168:171], v[72:75]
  v_mfma_f32_16x16x32_bf16 v[88:91], a[248:251], v[168:171], v[88:91]
  v_mfma_f32_16x16x32_bf16 v[104:107], a[252:255], v[168:171], v[104:107]
  s_add_u32 m0, s84, 20480
  s_add_u32 s78, s78, 65536
  buffer_load_dwordx4 v6, s[56:59], s78 offen offset:0 lds
  s_waitcnt vmcnt(23)
  v_mfma_f32_16x16x32_bf16 v[60:63], a[240:243], v[172:175], v[60:63]
  v_mfma_f32_16x16x32_bf16 v[76:79], a[244:247], v[172:175], v[76:79]
  v_mfma_f32_16x16x32_bf16 v[92:95], a[248:251], v[172:175], v[92:95]
  v_mfma_f32_16x16x32_bf16 v[108:111], a[252:255], v[172:175], v[108:111]
  buffer_load_dwordx4 v13, s[56:59], s78 offen offset:1024 lds
  s_waitcnt vmcnt(23)
  v_mfma_f32_16x16x32_bf16 v[64:67], a[240:243], v[176:179], v[64:67]
  v_mfma_f32_16x16x32_bf16 v[80:83], a[244:247], v[176:179], v[80:83]
  v_mfma_f32_16x16x32_bf16 v[96:99], a[248:251], v[176:179], v[96:99]
  v_mfma_f32_16x16x32_bf16 v[112:115], a[252:255], v[176:179], v[112:115]
  s_add_u32 m0, s84, 22528
  s_add_u32 s78, s78, 65536
  buffer_load_dwordx4 v6, s[56:59], s78 offen offset:0 lds
  s_waitcnt vmcnt(19)
  ds_read_b64_tr_b16 a[0:1], v2 offset:0
  ds_read_b64_tr_b16 a[2:3], v2 offset:2048
  ds_read_b64_tr_b16 a[4:5], v3 offset:0
  ds_read_b64_tr_b16 a[6:7], v3 offset:2048
  ds_read_b64_tr_b16 a[8:9], v4 offset:0
  ds_read_b64_tr_b16 a[10:11], v4 offset:2048
  ds_read_b64_tr_b16 a[12:13], v5 offset:0
  ds_read_b64_tr_b16 a[14:15], v5 offset:2048
  v_mfma_f32_16x16x32_bf16 v[68:71], a[240:243], v[180:183], v[68:71]
  v_mfma_f32_16x16x32_bf16 v[84:87], a[244:247], v[180:183], v[84:87]
  v_mfma_f32_16x16x32_bf16 v[100:103], a[248:251], v[180:183], v[100:103]
  v_mfma_f32_16x16x32_bf16 v[116:119], a[252:255], v[180:183], v[116:119]
  buffer_load_dwordx4 v13, s[56:59], s78 offen offset:1024 lds
  s_barrier
  s_xor_b32 s79, s64, 1
  s_mul_i32 s79, s79, 12288
  s_add_u32 s79, s79, 0
  v_add_u32 v7, s79, v1
  ds_write_b128 v7, v[64:67] offset:0
  ds_write_b128 v7, v[68:71] offset:1024
  ds_write_b128 v7, v[80:83] offset:2048
  ds_write_b128 v7, v[84:87] offset:3072
  s_xor_b32 s79, s64, 2
  s_mul_i32 s79, s79, 12288
  s_add_u32 s79, s79, 4096
  v_add_u32 v7, s79, v1
  ds_write_b128 v7, v[88:91] offset:0
  ds_write_b128 v7, v[92:95] offset:1024
  ds_write_b128 v7, v[104:107] offset:2048
  ds_write_b128 v7, v[108:111] offset:3072
  s_xor_b32 s79, s64, 3
  s_mul_i32 s79, s79, 12288
  s_add_u32 s79, s79, 8192
  v_add_u32 v7, s79, v1
  ds_write_b128 v7, v[96:99] offset:0
  ds_write_b128 v7, v[100:103] offset:1024
  ds_write_b128 v7, v[112:115] offset:2048
  ds_write_b128 v7, v[116:119] offset:3072
  s_waitcnt lgkmcnt(0)
  s_barrier
  s_mul_i32 s79, s64, 12288
  v_add_u32 v7, s79, v1
  ds_read_b128 v[120:123], v7 offset:0
  ds_read_b128 v[124:127], v7 offset:1024
  ds_read_b128 v[128:131], v7 offset:2048
  ds_read_b128 v[132:135], v7 offset:3072
  ds_read_b128 v[136:139], v7 offset:4096
  ds_read_b128 v[140:143], v7 offset:5120
  ds_read_b128 v[144:147], v7 offset:6144
  ds_read_b128 v[148:151], v7 offset:7168
  ds_read_b128 v[152:155], v7 offset:8192
  ds_read_b128 v[156:159], v7 offset:9216
  ds_read_b128 v[160:163], v7 offset:10240
  ds_read_b128 v[164:167], v7 offset:11264
  s_waitcnt lgkmcnt(8)
  v_pk_add_f32 v[56:57], v[56:57], v[120:121]
  v_pk_add_f32 v[58:59], v[58:59], v[122:123]
  v_pk_add_f32 v[60:61], v[60:61], v[124:125]
  v_pk_add_f32 v[62:63], v[62:63], v[126:127]
  v_pk_add_f32 v[72:73], v[72:73], v[128:129]
  v_pk_add_f32 v[74:75], v[74:75], v[130:131]
  v_pk_add_f32 v[76:77], v[76:77], v[132:133]
  v_pk_add_f32 v[78:79], v[78:79], v[134:135]
  s_waitcnt lgkmcnt(4)
  v_pk_add_f32 v[56:57], v[56:57], v[136:137]
  v_pk_add_f32 v[58:59], v[58:59], v[138:139]
  v_pk_add_f32 v[60:61], v[60:61], v[140:141]
  v_pk_add_f32 v[62:63], v[62:63], v[142:143]
  v_pk_add_f32 v[72:73], v[72:73], v[144:145]
  v_pk_add_f32 v[74:75], v[74:75], v[146:147]
  v_pk_add_f32 v[76:77], v[76:77], v[148:149]
  v_pk_add_f32 v[78:79], v[78:79], v[150:151]
  s_waitcnt lgkmcnt(0)
  v_pk_add_f32 v[56:57], v[56:57], v[152:153]
  v_pk_add_f32 v[58:59], v[58:59], v[154:155]
  v_pk_add_f32 v[60:61], v[60:61], v[156:157]
  v_pk_add_f32 v[62:63], v[62:63], v[158:159]
  v_pk_add_f32 v[72:73], v[72:73], v[160:161]
  v_pk_add_f32 v[74:75], v[74:75], v[162:163]
  v_pk_add_f32 v[76:77], v[76:77], v[164:165]
  v_pk_add_f32 v[78:79], v[78:79], v[166:167]
  v_lshlrev_b32 v16, 16, v32
  v_and_b32 v17, s72, v32
  v_lshlrev_b32 v18, 16, v33
  v_and_b32 v19, s72, v33
  v_lshlrev_b32 v20, 16, v34
  v_and_b32 v21, s72, v34
  v_lshlrev_b32 v22, 16, v35
  v_and_b32 v23, s72, v35
  s_mov_b32 s100, 0xbdd2d3e8
  s_mov_b32 s101, 0xbdd2d3e8
  v_mov_b32 v30, 0xc0135761
  v_mov_b32 v31, 0xc0135761
  v_pk_add_f32 v[56:57], v[56:57], v[16:17]
  v_pk_add_f32 v[58:59], v[58:59], v[18:19]
  v_pk_add_f32 v[60:61], v[60:61], v[16:17]
  v_pk_add_f32 v[62:63], v[62:63], v[18:19]
  v_pk_add_f32 v[72:73], v[72:73], v[20:21]
  v_pk_add_f32 v[74:75], v[74:75], v[22:23]
  v_pk_add_f32 v[76:77], v[76:77], v[20:21]
  v_pk_add_f32 v[78:79], v[78:79], v[22:23]
  v_pk_mul_f32 v[120:121], v[56:57], v[56:57]
  v_pk_mul_f32 v[122:123], v[58:59], v[58:59]
  v_pk_mul_f32 v[124:125], v[60:61], v[60:61]
  v_pk_mul_f32 v[126:127], v[62:63], v[62:63]
  v_pk_mul_f32 v[128:129], v[72:73], v[72:73]
  v_pk_mul_f32 v[130:131], v[74:75], v[74:75]
  v_pk_mul_f32 v[132:133], v[76:77], v[76:77]
  v_pk_mul_f32 v[134:135], v[78:79], v[78:79]
  v_pk_fma_f32 v[120:121], v[120:121], s[100:101], v[30:31]
  v_pk_fma_f32 v[122:123], v[122:123], s[100:101], v[30:31]
  v_pk_fma_f32 v[124:125], v[124:125], s[100:101], v[30:31]
  v_pk_fma_f32 v[126:127], v[126:127], s[100:101], v[30:31]
  v_pk_fma_f32 v[128:129], v[128:129], s[100:101], v[30:31]
  v_pk_fma_f32 v[130:131], v[130:131], s[100:101], v[30:31]
  v_pk_fma_f32 v[132:133], v[132:133], s[100:101], v[30:31]
  v_pk_fma_f32 v[134:135], v[134:135], s[100:101], v[30:31]
  v_pk_mul_f32 v[120:121], v[120:121], v[56:57]
  v_pk_mul_f32 v[122:123], v[122:123], v[58:59]
  v_pk_mul_f32 v[124:125], v[124:125], v[60:61]
  v_pk_mul_f32 v[126:127], v[126:127], v[62:63]
  v_pk_mul_f32 v[128:129], v[128:129], v[72:73]
  v_pk_mul_f32 v[130:131], v[130:131], v[74:75]
  v_pk_mul_f32 v[132:133], v[132:133], v[76:77]
  v_pk_mul_f32 v[134:135], v[134:135], v[78:79]
  v_exp_f32 v120, v120
  v_exp_f32 v121, v121
  v_exp_f32 v122, v122
  v_exp_f32 v123, v123
  v_exp_f32 v124, v124
  v_exp_f32 v125, v125
  v_exp_f32 v126, v126
  v_exp_f32 v127, v127
  v_exp_f32 v128, v128
  v_exp_f32 v129, v129
  v_exp_f32 v130, v130
  v_exp_f32 v131, v131
  v_exp_f32 v132, v132
  v_exp_f32 v133, v133
  v_exp_f32 v134, v134
  v_exp_f32 v135, v135
  v_pk_add_f32 v[120:121], v[120:121], 1.0 op_sel_hi:[1,0]
  v_pk_add_f32 v[122:123], v[122:123], 1.0 op_sel_hi:[1,0]
  v_pk_add_f32 v[124:125], v[124:125], 1.0 op_sel_hi:[1,0]
  v_pk_add_f32 v[126:127], v[126:127], 1.0 op_sel_hi:[1,0]
  v_pk_add_f32 v[128:129], v[128:129], 1.0 op_sel_hi:[1,0]
  v_pk_add_f32 v[130:131], v[130:131], 1.0 op_sel_hi:[1,0]
  v_pk_add_f32 v[132:133], v[132:133], 1.0 op_sel_hi:[1,0]
  v_pk_add_f32 v[134:135], v[134:135], 1.0 op_sel_hi:[1,0]
  v_rcp_f32 v120, v120
  v_rcp_f32 v121, v121
  v_rcp_f32 v122, v122
  v_rcp_f32 v123, v123
  v_rcp_f32 v124, v124
  v_rcp_f32 v125, v125
  v_rcp_f32 v126, v126
  v_rcp_f32 v127, v127
  v_rcp_f32 v128, v128
  v_rcp_f32 v129, v129
  v_rcp_f32 v130, v130
  v_rcp_f32 v131, v131
  v_rcp_f32 v132, v132
  v_rcp_f32 v133, v133
  v_rcp_f32 v134, v134
  v_rcp_f32 v135, v135
  v_pk_mul_f32 v[56:57], v[56:57], v[120:121]
  v_pk_mul_f32 v[58:59], v[58:59], v[122:123]
  v_pk_mul_f32 v[60:61], v[60:61], v[124:125]
  v_pk_mul_f32 v[62:63], v[62:63], v[126:127]
  v_pk_mul_f32 v[72:73], v[72:73], v[128:129]
  v_pk_mul_f32 v[74:75], v[74:75], v[130:131]
  v_pk_mul_f32 v[76:77], v[76:77], v[132:133]
  v_pk_mul_f32 v[78:79], v[78:79], v[134:135]
  v_cvt_pk_bf16_f32 v136, v56, v57
  v_cvt_pk_bf16_f32 v137, v58, v59
  v_cvt_pk_bf16_f32 v138, v72, v73
  v_cvt_pk_bf16_f32 v139, v74, v75
  v_cvt_pk_bf16_f32 v140, v60, v61
  v_cvt_pk_bf16_f32 v141, v62, v63
  v_cvt_pk_bf16_f32 v142, v76, v77
  v_cvt_pk_bf16_f32 v143, v78, v79
  s_mul_i32 s79, s69, 229376
  s_lshl_b32 s80, s70, 13
  s_add_u32 s79, s79, s80
  s_lshl_b32 s80, s65, 12
  s_add_u32 s79, s79, s80
  s_lshl_b32 s80, s66, 11
  s_add_u32 s79, s79, s80
  s_add_u32 s79, s79, 2097152
  buffer_store_dwordx4 v[136:139], v1, s[44:47], s79 offen offset:0 sc1
  buffer_store_dwordx4 v[140:143], v1, s[44:47], s79 offen offset:1024 sc1
  s_lshl_b32 s79, s68, 14
  s_add_u32 s79, s79, 1851392
  s_add_u32 s48, s36, s79
  s_addc_u32 s49, s37, 0
  s_and_b32 s49, s49, 0xffff
  s_mov_b32 s50, 16384
  s_mov_b32 s51, 0x20000
  v_lshrrev_b32 v8, 4, v0
  v_lshlrev_b32 v8, 12, v8
  v_and_b32 v9, 15, v0
  v_lshlrev_b32 v9, 3, v9
  v_add_u32 v8, v8, v9
  s_sub_u32 s79, s67, 32
  s_lshl_b32 s79, s79, 9
  s_lshl_b32 s80, s64, 7
  s_add_u32 s79, s79, s80
  v_add_u32 v8, s79, v8
  v_add_u32 v200, 0, v8
  v_add_u32 v201, 512, v8
  v_add_u32 v202, 1024, v8
  v_add_u32 v203, 1536, v8
  v_add_u32 v204, 2048, v8
  v_add_u32 v205, 2560, v8
  v_add_u32 v206, 3072, v8
  v_add_u32 v207, 3584, v8
  buffer_load_dwordx2 v[16:17], v200, s[48:51], 0 offen sc1
  buffer_load_dwordx2 v[18:19], v201, s[48:51], 0 offen sc1
  buffer_load_dwordx2 v[20:21], v202, s[48:51], 0 offen sc1
  buffer_load_dwordx2 v[22:23], v203, s[48:51], 0 offen sc1
  buffer_load_dwordx2 v[24:25], v204, s[48:51], 0 offen sc1
  buffer_load_dwordx2 v[26:27], v205, s[48:51], 0 offen sc1
  buffer_load_dwordx2 v[28:29], v206, s[48:51], 0 offen sc1
  buffer_load_dwordx2 v[30:31], v207, s[48:51], 0 offen sc1
  s_mul_i32 s79, s64, 7
  s_lshr_b32 s80, s79, 2
  s_mul_i32 s81, s67, 7
  s_add_u32 s81, s81, s80
  s_add_u32 s82, s79, 6
  s_lshr_b32 s82, s82, 2
  s_sub_u32 s82, s82, s80
  v_min_u32 v14, s82, v0
  v_add_u32 v14, s81, v14
  v_lshlrev_b32 v14, 6, v14
  v_add_u32 v14, 1966080, v14
  v_min_u32 v8, 13, v0
  v_lshlrev_b32 v9, 6, v8
  s_mul_i32 s80, s68, 28
  s_add_u32 s80, s80, s79
  s_lshl_b32 s80, s80, 6
  s_add_u32 s80, s80, 1982464
  s_lshl_b32 s79, s79, 6
  s_add_u32 s79, s79, 1998400
  v_mov_b32 v10, s80
  v_mov_b32 v11, s79
  v_cmp_gt_u32 vcc, 7, v8
  s_nop 1
  v_cndmask_b32 v10, v11, v10, vcc
  v_add_u32 v12, v9, v10
  s_mul_i32 s90, s68, 229376
  s_mul_i32 s79, s64, 57344
  s_add_u32 s90, s90, s79
  s_add_u32 s90, s90, 2097152
  s_lshl_b32 s80, s65, 11
  s_xor_b32 s81, s80, 2048
  s_add_u32 s92, s90, s81
  s_add_u32 s90, s90, s80
  s_mul_i32 s22, s68, 114688
  s_mul_i32 s79, s64, 28672
  s_add_u32 s22, s22, s79
  s_add_u32 s22, s22, 7864320
  s_add_u32 s23, s22, s81
  s_add_u32 s22, s22, s80
  s_mul_i32 s38, s67, 114688
  s_add_u32 s38, s38, s79
  s_add_u32 s38, s38, 4194304
  s_lshl_b32 s80, s66, 11
  s_xor_b32 s81, s80, 2048
  s_add_u32 s39, s38, s81
  s_add_u32 s38, s38, s80
  global_load_dword v54, v12, s[36:37] sc1
  s_add_u32 m0, s84, 0
  s_add_u32 s78, s78, 65536
  buffer_load_dwordx4 v6, s[56:59], s78 offen offset:0 lds
  buffer_load_dwordx4 v13, s[56:59], s78 offen offset:1024 lds
  s_add_u32 m0, s84, 2048
  s_add_u32 s78, s78, 65536
  buffer_load_dwordx4 v6, s[56:59], s78 offen offset:0 lds
  s_waitcnt vmcnt(30)
  ds_read_b64_tr_b16 a[16:17], v2 offset:4096
  ds_read_b64_tr_b16 a[18:19], v2 offset:6144
  ds_read_b64_tr_b16 a[20:21], v3 offset:4096
  ds_read_b64_tr_b16 a[22:23], v3 offset:6144
  ds_read_b64_tr_b16 a[24:25], v4 offset:4096
  ds_read_b64_tr_b16 a[26:27], v4 offset:6144
  ds_read_b64_tr_b16 a[28:29], v5 offset:4096
  ds_read_b64_tr_b16 a[30:31], v5 offset:6144
  buffer_load_dwordx4 v13, s[56:59], s78 offen offset:1024 lds
  s_waitcnt vmcnt(13)
  s_barrier
  s_cmp_lg_u32 s64, 0
  s_cbranch_scc1 L_flag_13
  s_mul_i32 s79, s69, 28
  s_add_u32 s79, s79, s70
  s_lshl_b32 s79, s79, 6
  s_add_u32 s79, s79, 1982464
  v_mov_b32 v8, 0
  v_mov_b32 v9, 1
  s_mov_b32 exec_lo, 1
  s_mov_b32 exec_hi, 0
  buffer_store_dword v9, v8, s[44:47], s79 offen sc1
  s_mov_b64 exec, -1
L_flag_13:
  s_branch L_g1join_12
L_nog1_11:
  s_lshr_b32 s85, s95, 1
  s_mul_i32 s85, s85, 7
  s_add_u32 s85, s85, s86
  s_sub_u32 s85, s85, 21
  s_cmp_ge_u32 s85, 28
  s_cbranch_scc1 L_nocp_14
  s_mov_b32 s50, 401408
  s_mov_b32 s51, 0x20000
  s_bitcmp1_b32 s85, 1
  s_cselect_b32 s48, s16, s14
  s_cselect_b32 s49, s17, s15
  v_and_b32 v9, 15, v0
  v_mul_u32_u24 v9, 896, v9
  v_lshrrev_b32 v10, 4, v0
  v_lshlrev_b32 v10, 4, v10
  v_add_u32 v10, v9, v10
  s_lshr_b32 s79, s85, 2
  s_lshl_b32 s79, s79, 7
  s_and_b32 s80, s85, 1
  s_lshl_b32 s80, s80, 6
  s_add_u32 s79, s79, s80
  s_mul_i32 s80, s64, 14336
  s_add_u32 s79, s79, s80
  buffer_load_dwordx4 v[56:59], v10, s[48:51], s79 offen
  s_add_u32 s79, s79, 57344
  buffer_load_dwordx4 v[60:63], v10, s[48:51], s79 offen
  s_add_u32 s79, s79, 57344
  buffer_load_dwordx4 v[64:67], v10, s[48:51], s79 offen
  s_add_u32 s79, s79, 57344
  buffer_load_dwordx4 v[68:71], v10, s[48:51], s79 offen
  s_add_u32 s79, s79, 57344
  buffer_load_dwordx4 v[72:75], v10, s[48:51], s79 offen
  s_add_u32 s79, s79, 57344
  buffer_load_dwordx4 v[76:79], v10, s[48:51], s79 offen
  s_add_u32 s79, s79, 57344
  buffer_load_dwordx4 v[80:83], v10, s[48:51], s79 offen
  s_lshl_b32 s79, s85, 12
  s_lshl_b32 s80, s64, 10
  s_add_u32 s79, s79, s80
  s_add_u32 s79, s79, 7864320
  s_waitcnt vmcnt(6)
  buffer_store_dwordx4 v[56:59], v1, s[44:47], s79 offen sc1
  s_add_u32 s79, s79, 114688
  s_waitcnt vmcnt(6)
  buffer_store_dwordx4 v[60:63], v1, s[44:47], s79 offen sc1
  s_add_u32 s79, s79, 114688
  s_waitcnt vmcnt(6)
  buffer_store_dwordx4 v[64:67], v1, s[44:47], s79 offen sc1
  s_add_u32 s79, s79, 114688
  s_waitcnt vmcnt(6)
  buffer_store_dwordx4 v[68:71], v1, s[44:47], s79 offen sc1
  s_add_u32 s79, s79, 114688
  s_waitcnt vmcnt(6)
  buffer_store_dwordx4 v[72:75], v1, s[44:47], s79 offen sc1
  s_add_u32 s79, s79, 114688
  s_waitcnt vmcnt(6)
  buffer_store_dwordx4 v[76:79], v1, s[44:47], s79 offen sc1
  s_add_u32 s79, s79, 114688
  s_waitcnt vmcnt(6)
  buffer_store_dwordx4 v[80:83], v1, s[44:47], s79 offen sc1
L_nocp_14:
  s_waitcnt vmcnt(0)
  s_barrier
  s_mov_b32 s80, 0
  s_cmp_lg_u32 s64, 0
  s_cbranch_scc1 L_flag_15
  s_mul_i32 s79, s80, 1
  s_add_u32 s79, s79, s85
  s_lshl_b32 s79, s79, 6
  s_add_u32 s79, s79, 1998848
  v_mov_b32 v8, 0
  v_mov_b32 v9, 1
  s_mov_b32 exec_lo, 1
  s_mov_b32 exec_hi, 0
  buffer_store_dword v9, v8, s[44:47], s79 offen sc1
  s_mov_b64 exec, -1
L_flag_15:
  ds_read_b64_tr_b16 a[192:193], v2 offset:0
  ds_read_b64_tr_b16 a[194:195], v2 offset:2048
  ds_read_b64_tr_b16 a[196:197], v3 offset:0
  ds_read_b64_tr_b16 a[198:199], v3 offset:2048
  ds_read_b64_tr_b16 a[200:201], v4 offset:0
  ds_read_b64_tr_b16 a[202:203], v4 offset:2048
  ds_read_b64_tr_b16 a[204:205], v5 offset:0
  ds_read_b64_tr_b16 a[206:207], v5 offset:2048
  ds_read_b64_tr_b16 a[208:209], v2 offset:4096
  ds_read_b64_tr_b16 a[210:211], v2 offset:6144
  ds_read_b64_tr_b16 a[212:213], v3 offset:4096
  ds_read_b64_tr_b16 a[214:215], v3 offset:6144
  ds_read_b64_tr_b16 a[216:217], v4 offset:4096
  ds_read_b64_tr_b16 a[218:219], v4 offset:6144
  ds_read_b64_tr_b16 a[220:221], v5 offset:4096
  ds_read_b64_tr_b16 a[222:223], v5 offset:6144
  ds_read_b64_tr_b16 a[224:225], v2 offset:8192
  ds_read_b64_tr_b16 a[226:227], v2 offset:10240
  ds_read_b64_tr_b16 a[228:229], v3 offset:8192
  ds_read_b64_tr_b16 a[230:231], v3 offset:10240
  ds_read_b64_tr_b16 a[232:233], v4 offset:8192
  ds_read_b64_tr_b16 a[234:235], v4 offset:10240
  ds_read_b64_tr_b16 a[236:237], v5 offset:8192
  ds_read_b64_tr_b16 a[238:239], v5 offset:10240
  ds_read_b64_tr_b16 a[240:241], v2 offset:12288
  ds_read_b64_tr_b16 a[242:243], v2 offset:14336
  ds_read_b64_tr_b16 a[244:245], v3 offset:12288
  ds_read_b64_tr_b16 a[246:247], v3 offset:14336
  ds_read_b64_tr_b16 a[248:249], v4 offset:12288
  ds_read_b64_tr_b16 a[250:251], v4 offset:14336
  ds_read_b64_tr_b16 a[252:253], v5 offset:12288
  ds_read_b64_tr_b16 a[254:255], v5 offset:14336
  s_waitcnt lgkmcnt(0)
  s_mov_b32 s56, s28
  s_and_b32 s57, s29, 0xffff
  s_mov_b32 s58, 7340032
  s_mov_b32 s59, 0x20000
  v_lshrrev_b32 v7, 3, v0
  v_and_b32 v8, 7, v0
  v_and_b32 v9, 6, v7
  v_xor_b32 v8, v8, v9
  v_lshlrev_b32 v8, 4, v8
  v_mul_u32_u24 v7, 4096, v7
  v_add_u32 v6, v7, v8
  v_add_u32 v13, 31744, v6
  v_lshrrev_b32 v7, 2, v0
  v_and_b32 v8, 6, v7
  v_bfe_u32 v9, v0, 1, 1
  v_xor_b32 v8, v8, v9
  v_lshlrev_b32 v8, 4, v8
  v_lshlrev_b32 v7, 7, v7
  v_add_u32 v7, v7, v8
  v_and_b32 v9, 1, v0
  v_lshlrev_b32 v9, 3, v9
  v_add_u32 v7, v7, v9
  s_lshl_b32 s79, s66, 6
  v_xor_b32 v7, s79, v7
  v_add_u32 v2, s84, v7
  v_xor_b32 v3, 32, v2
  v_xor_b32 v4, 64, v2
  v_xor_b32 v5, 96, v2
  s_mul_i32 s96, s64, 1835008
  s_lshl_b32 s79, s67, 7
  s_add_u32 s96, s96, s79
  s_mov_b32 s78, s96
  s_add_u32 m0, s84, 0
  s_nop 0
  buffer_load_dwordx4 v6, s[56:59], s78 offen offset:0 lds
  buffer_load_dwordx4 v13, s[56:59], s78 offen offset:1024 lds
  s_add_u32 m0, s84, 2048
  s_add_u32 s78, s78, 65536
  buffer_load_dwordx4 v6, s[56:59], s78 offen offset:0 lds
  buffer_load_dwordx4 v13, s[56:59], s78 offen offset:1024 lds
  s_add_u32 m0, s84, 4096
  s_add_u32 s78, s78, 65536
  buffer_load_dwordx4 v6, s[56:59], s78 offen offset:0 lds
  buffer_load_dwordx4 v13, s[56:59], s78 offen offset:1024 lds
  s_add_u32 m0, s84, 6144
  s_add_u32 s78, s78, 65536
  buffer_load_dwordx4 v6, s[56:59], s78 offen offset:0 lds
  buffer_load_dwordx4 v13, s[56:59], s78 offen offset:1024 lds
  s_add_u32 m0, s84, 8192
  s_add_u32 s78, s78, 65536
  buffer_load_dwordx4 v6, s[56:59], s78 offen offset:0 lds
  buffer_load_dwordx4 v13, s[56:59], s78 offen offset:1024 lds
  s_add_u32 m0, s84, 10240
  s_add_u32 s78, s78, 65536
  buffer_load_dwordx4 v6, s[56:59], s78 offen offset:0 lds
  buffer_load_dwordx4 v13, s[56:59], s78 offen offset:1024 lds
  s_add_u32 m0, s84, 12288
  s_add_u32 s78, s78, 65536
  buffer_load_dwordx4 v6, s[56:59], s78 offen offset:0 lds
  buffer_load_dwordx4 v13, s[56:59], s78 offen offset:1024 lds
  s_add_u32 m0, s84, 14336
  s_add_u32 s78, s78, 65536
  buffer_load_dwordx4 v6, s[56:59], s78 offen offset:0 lds
  buffer_load_dwordx4 v13, s[56:59], s78 offen offset:1024 lds
  s_add_u32 m0, s84, 16384
  s_add_u32 s78, s78, 65536
  buffer_load_dwordx4 v6, s[56:59], s78 offen offset:0 lds
  buffer_load_dwordx4 v13, s[56:59], s78 offen offset:1024 lds
  s_add_u32 m0, s84, 18432
  s_add_u32 s78, s78, 65536
  buffer_load_dwordx4 v6, s[56:59], s78 offen offset:0 lds
  buffer_load_dwordx4 v13, s[56:59], s78 offen offset:1024 lds
  s_add_u32 m0, s84, 20480
  s_add_u32 s78, s78, 65536
  buffer_load_dwordx4 v6, s[56:59], s78 offen offset:0 lds
  buffer_load_dwordx4 v13, s[56:59], s78 offen offset:1024 lds
  s_add_u32 m0, s84, 22528
  s_add_u32 s78, s78, 65536
  buffer_load_dwordx4 v6, s[56:59], s78 offen offset:0 lds
  s_waitcnt vmcnt(19)
  ds_read_b64_tr_b16 a[0:1], v2 offset:0
  ds_read_b64_tr_b16 a[2:3], v2 offset:2048
  ds_read_b64_tr_b16 a[4:5], v3 offset:0
  ds_read_b64_tr_b16 a[6:7], v3 offset:2048
  ds_read_b64_tr_b16 a[8:9], v4 offset:0
  ds_read_b64_tr_b16 a[10:11], v4 offset:2048
  ds_read_b64_tr_b16 a[12:13], v5 offset:0
  ds_read_b64_tr_b16 a[14:15], v5 offset:2048
  buffer_load_dwordx4 v13, s[56:59], s78 offen offset:1024 lds
  s_waitcnt lgkmcnt(0)
  s_add_u32 m0, s84, 0
  s_add_u32 s78, s78, 65536
  buffer_load_dwordx4 v6, s[56:59], s78 offen offset:0 lds
  buffer_load_dwordx4 v13, s[56:59], s78 offen offset:1024 lds
  s_add_u32 m0, s84, 2048
  s_add_u32 s78, s78, 65536
  buffer_load_dwordx4 v6, s[56:59], s78 offen offset:0 lds
  s_waitcnt vmcnt(19)
  ds_read_b64_tr_b16 a[16:17], v2 offset:4096
  ds_read_b64_tr_b16 a[18:19], v2 offset:6144
  ds_read_b64_tr_b16 a[20:21], v3 offset:4096
  ds_read_b64_tr_b16 a[22:23], v3 offset:6144
  ds_read_b64_tr_b16 a[24:25], v4 offset:4096
  ds_read_b64_tr_b16 a[26:27], v4 offset:6144
  ds_read_b64_tr_b16 a[28:29], v5 offset:4096
  ds_read_b64_tr_b16 a[30:31], v5 offset:6144
  buffer_load_dwordx4 v13, s[56:59], s78 offen offset:1024 lds
  s_lshl_b32 s79, s68, 14
  s_add_u32 s79, s79, 1851392
  s_add_u32 s48, s36, s79
  s_addc_u32 s49, s37, 0
  s_and_b32 s49, s49, 0xffff
  s_mov_b32 s50, 16384
  s_mov_b32 s51, 0x20000
  v_lshrrev_b32 v8, 4, v0
  v_lshlrev_b32 v8, 12, v8
  v_and_b32 v9, 15, v0
  v_lshlrev_b32 v9, 3, v9
  v_add_u32 v8, v8, v9
  s_sub_u32 s79, s67, 32
  s_lshl_b32 s79, s79, 9
  s_lshl_b32 s80, s64, 7
  s_add_u32 s79, s79, s80
  v_add_u32 v8, s79, v8
  v_add_u32 v200, 0, v8
  v_add_u32 v201, 512, v8
  v_add_u32 v202, 1024, v8
  v_add_u32 v203, 1536, v8
  v_add_u32 v204, 2048, v8
  v_add_u32 v205, 2560, v8
  v_add_u32 v206, 3072, v8
  v_add_u32 v207, 3584, v8
  buffer_load_dwordx2 v[16:17], v200, s[48:51], 0 offen sc1
  buffer_load_dwordx2 v[18:19], v201, s[48:51], 0 offen sc1
  buffer_load_dwordx2 v[20:21], v202, s[48:51], 0 offen sc1
  buffer_load_dwordx2 v[22:23], v203, s[48:51], 0 offen sc1
  buffer_load_dwordx2 v[24:25], v204, s[48:51], 0 offen sc1
  buffer_load_dwordx2 v[26:27], v205, s[48:51], 0 offen sc1
  buffer_load_dwordx2 v[28:29], v206, s[48:51], 0 offen sc1
  buffer_load_dwordx2 v[30:31], v207, s[48:51], 0 offen sc1
  s_mul_i32 s79, s64, 7
  s_lshr_b32 s80, s79, 2
  s_mul_i32 s81, s67, 7
  s_add_u32 s81, s81, s80
  s_add_u32 s82, s79, 6
  s_lshr_b32 s82, s82, 2
  s_sub_u32 s82, s82, s80
  v_min_u32 v14, s82, v0
  v_add_u32 v14, s81, v14
  v_lshlrev_b32 v14, 6, v14
  v_add_u32 v14, 1966080, v14
  v_min_u32 v8, 13, v0
  v_lshlrev_b32 v9, 6, v8
  s_mul_i32 s80, s68, 28
  s_add_u32 s80, s80, s79
  s_lshl_b32 s80, s80, 6
  s_add_u32 s80, s80, 1982464
  s_lshl_b32 s79, s79, 6
  s_add_u32 s79, s79, 1998400
  v_mov_b32 v10, s80
  v_mov_b32 v11, s79
  v_cmp_gt_u32 vcc, 7, v8
  s_nop 1
  v_cndmask_b32 v10, v11, v10, vcc
  v_add_u32 v12, v9, v10
  s_mul_i32 s90, s68, 229376
  s_mul_i32 s79, s64, 57344
  s_add_u32 s90, s90, s79
  s_add_u32 s90, s90, 2097152
  s_lshl_b32 s80, s65, 11
  s_xor_b32 s81, s80, 2048
  s_add_u32 s92, s90, s81
  s_add_u32 s90, s90, s80
  s_mul_i32 s22, s68, 114688
  s_mul_i32 s79, s64, 28672
  s_add_u32 s22, s22, s79
  s_add_u32 s22, s22, 7864320
  s_add_u32 s23, s22, s81
  s_add_u32 s22, s22, s80
  s_mul_i32 s38, s67, 114688
  s_add_u32 s38, s38, s79
  s_add_u32 s38, s38, 4194304
  s_lshl_b32 s80, s66, 11
  s_xor_b32 s81, s80, 2048
  s_add_u32 s39, s38, s81
  s_add_u32 s38, s38, s80
  global_load_dword v54, v12, s[36:37] sc1
L_g1join_12:
  s_waitcnt vmcnt(0)
  s_mov_b32 exec_lo, 0x3f80
  s_mov_b32 exec_hi, 0
  v_cmp_gt_u32 vcc, 1, v54
  s_cbranch_vccz L_cfd_17
  s_mov_b32 s83, 0x40000
L_cf_16:
  global_load_dword v54, v12, s[36:37] sc1
  s_waitcnt vmcnt(0)
  v_cmp_gt_u32 vcc, 1, v54
  s_cbranch_vccz L_cfd_17
  s_sleep 4
  s_sub_u32 s83, s83, 1
  s_cbranch_scc0 L_cf_16
L_cfd_17:
  s_mov_b64 exec, -1
  s_mov_b32 s83, 0x40000
L_pollE_18:
  v_max3_u32 v8, v16, v17, v18
  v_max3_u32 v8, v8, v19, v20
  v_max3_u32 v8, v8, v21, v22
  v_max3_u32 v8, v8, v23, v24
  v_max3_u32 v8, v8, v25, v26
  v_max3_u32 v8, v8, v27, v28
  v_max3_u32 v8, v8, v29, v30
  v_max_u32 v8, v8, v31
  v_cmp_eq_u32 vcc, -1, v8
  s_cbranch_vccz L_pollEd_19
  buffer_load_dwordx2 v[16:17], v200, s[48:51], 0 offen sc1
  buffer_load_dwordx2 v[18:19], v201, s[48:51], 0 offen sc1
  buffer_load_dwordx2 v[20:21], v202, s[48:51], 0 offen sc1
  buffer_load_dwordx2 v[22:23], v203, s[48:51], 0 offen sc1
  buffer_load_dwordx2 v[24:25], v204, s[48:51], 0 offen sc1
  buffer_load_dwordx2 v[26:27], v205, s[48:51], 0 offen sc1
  buffer_load_dwordx2 v[28:29], v206, s[48:51], 0 offen sc1
  buffer_load_dwordx2 v[30:31], v207, s[48:51], 0 offen sc1
  s_waitcnt vmcnt(0)
  s_sleep 4
  s_sub_u32 s83, s83, 1
  s_cbranch_scc0 L_pollE_18
L_pollEd_19:
  v_fma_f32 v36, v48, v16, v18
  v_fma_f32 v37, v48, v17, v19
  v_fma_f32 v36, -v49, v17, v36
  v_fma_f32 v17, v49, v16, v37
  v_mov_b32 v16, v36
  v_fma_f32 v36, v48, v16, v20
  v_fma_f32 v37, v48, v17, v21
  v_fma_f32 v36, -v49, v17, v36
  v_fma_f32 v17, v49, v16, v37
  v_mov_b32 v16, v36
  v_fma_f32 v36, v48, v16, v22
  s_add_u32 s91, s22, 20480
  buffer_load_dwordx4 a[224:227], v1, s[44:47], s91 offen offset:0 sc1
  v_fma_f32 v37, v48, v17, v23
  v_fma_f32 v36, -v49, v17, v36
  v_fma_f32 v17, v49, v16, v37
  v_mov_b32 v16, v36
  v_fma_f32 v36, v48, v16, v24
  v_fma_f32 v37, v48, v17, v25
  v_fma_f32 v36, -v49, v17, v36
  v_fma_f32 v17, v49, v16, v37
  v_mov_b32 v16, v36
  v_fma_f32 v36, v48, v16, v26
  v_fma_f32 v37, v48, v17, v27
  s_add_u32 s91, s22, 20480
  buffer_load_dwordx4 a[228:231], v1, s[44:47], s91 offen offset:1024 sc1
  v_fma_f32 v36, -v49, v17, v36
  v_fma_f32 v17, v49, v16, v37
  v_mov_b32 v16, v36
  v_fma_f32 v36, v48, v16, v28
  v_fma_f32 v37, v48, v17, v29
  v_fma_f32 v36, -v49, v17, v36
  v_fma_f32 v17, v49, v16, v37
  v_mov_b32 v16, v36
  v_fma_f32 v36, v48, v16, v30
  v_fma_f32 v37, v48, v17, v31
  v_fma_f32 v36, -v49, v17, v36
  s_add_u32 s91, s23, 20480
  buffer_load_dwordx4 a[232:235], v1, s[44:47], s91 offen offset:0 sc1
  v_fma_f32 v17, v49, v16, v37
  v_mov_b32 v16, v36
  v_mov_b32 v20, v16
  v_mov_b32 v21, v16
  s_nop 1
  v_permlane16_swap_b32 v20, v21
  v_mov_b32 v22, v20
  v_mov_b32 v23, v21
  s_nop 0
  v_permlane32_swap_b32 v20, v22
  v_permlane32_swap_b32 v21, v23
  v_mov_b32 v24, v17
  v_mov_b32 v25, v17
  s_add_u32 s91, s23, 20480
  buffer_load_dwordx4 a[236:239], v1, s[44:47], s91 offen offset:1024 sc1
  v_permlane16_swap_b32 v24, v25
  v_mov_b32 v26, v24
  v_mov_b32 v27, v25
  s_nop 0
  v_permlane32_swap_b32 v24, v26
  v_permlane32_swap_b32 v25, v27
  v_fma_f32 v28, v50, v20, v21
  v_fma_f32 v29, v50, v24, v25
  v_fma_f32 v28, -v51, v24, v28
  v_fma_f32 v25, v51, v20, v29
  v_mov_b32 v21, v28
  v_fma_f32 v28, v50, v21, v22
  s_add_u32 s91, s22, 24576
  buffer_load_dwordx4 a[240:243], v1, s[44:47], s91 offen offset:0 sc1
  v_fma_f32 v29, v50, v25, v26
  v_fma_f32 v28, -v51, v25, v28
  v_fma_f32 v26, v51, v21, v29
  v_mov_b32 v22, v28
  v_fma_f32 v28, v50, v22, v23
  v_fma_f32 v29, v50, v26, v27
  v_fma_f32 v28, -v51, v26, v28
  v_fma_f32 v27, v51, v22, v29
  v_mov_b32 v23, v28
  v_fma_f32 v28, v46, v23, v44
  v_fma_f32 v29, v46, v27, v45
  s_add_u32 s91, s22, 24576
  buffer_load_dwordx4 a[244:247], v1, s[44:47], s91 offen offset:1024 sc1
  v_fma_f32 v28, -v47, v27, v28
  v_fma_f32 v45, v47, v23, v29
  v_mov_b32 v44, v28
  v_fma_f32 v36, v40, v44, v224
  v_fma_f32 v37, v40, v45, v240
  v_fma_f32 v36, -v41, v45, v36
  v_fma_f32 v45, v41, v44, v37
  v_mul_f32 v224, v42, v36
  v_mul_f32 v240, v43, v36
  v_fma_f32 v224, v43, v45, v224
  v_fma_f32 v240, -v42, v45, v240
  s_add_u32 s91, s23, 24576
  buffer_load_dwordx4 a[248:251], v1, s[44:47], s91 offen offset:0 sc1
  v_fma_f32 v44, v40, v36, v225
  v_fma_f32 v37, v40, v45, v241
  v_fma_f32 v44, -v41, v45, v44
  v_fma_f32 v45, v41, v36, v37
  v_mul_f32 v225, v42, v44
  v_mul_f32 v241, v43, v44
  v_fma_f32 v225, v43, v45, v225
  v_fma_f32 v241, -v42, v45, v241
  v_fma_f32 v36, v40, v44, v226
  v_fma_f32 v37, v40, v45, v242
  v_fma_f32 v36, -v41, v45, v36
  s_add_u32 s91, s23, 24576
  buffer_load_dwordx4 a[252:255], v1, s[44:47], s91 offen offset:1024 sc1
  v_fma_f32 v45, v41, v44, v37
  v_mul_f32 v226, v42, v36
  v_mul_f32 v242, v43, v36
  v_fma_f32 v226, v43, v45, v226
  v_fma_f32 v242, -v42, v45, v242
  v_fma_f32 v44, v40, v36, v227
  v_fma_f32 v37, v40, v45, v243
  v_fma_f32 v44, -v41, v45, v44
  v_fma_f32 v45, v41, v36, v37
  v_mul_f32 v227, v42, v44
  v_mul_f32 v243, v43, v44
  s_waitcnt lgkmcnt(0)
  s_add_u32 m0, s84, 4096
  s_add_u32 s78, s78, 65536
  buffer_load_dwordx4 v6, s[56:59], s78 offen offset:0 lds
  v_fma_f32 v227, v43, v45, v227
  v_fma_f32 v243, -v42, v45, v243
  v_fma_f32 v36, v40, v44, v228
  v_fma_f32 v37, v40, v45, v244
  v_fma_f32 v36, -v41, v45, v36
  v_fma_f32 v45, v41, v44, v37
  v_mul_f32 v228, v42, v36
  v_mul_f32 v244, v43, v36
  v_fma_f32 v228, v43, v45, v228
  v_fma_f32 v244, -v42, v45, v244
  v_fma_f32 v44, v40, v36, v229
  buffer_load_dwordx4 v13, s[56:59], s78 offen offset:1024 lds
  v_fma_f32 v37, v40, v45, v245
  v_fma_f32 v44, -v41, v45, v44
  v_fma_f32 v45, v41, v36, v37
  v_mul_f32 v229, v42, v44
  v_mul_f32 v245, v43, v44
  v_fma_f32 v229, v43, v45, v229
  v_fma_f32 v245, -v42, v45, v245
  v_fma_f32 v36, v40, v44, v230
  v_fma_f32 v37, v40, v45, v246
  v_fma_f32 v36, -v41, v45, v36
  v_fma_f32 v45, v41, v44, v37
  s_add_u32 m0, s84, 6144
  s_add_u32 s78, s78, 65536
  buffer_load_dwordx4 v6, s[56:59], s78 offen offset:0 lds
  ds_read_b64_tr_b16 a[32:33], v2 offset:8192
  ds_read_b64_tr_b16 a[34:35], v2 offset:10240
  ds_read_b64_tr_b16 a[36:37], v3 offset:8192
  ds_read_b64_tr_b16 a[38:39], v3 offset:10240
  ds_read_b64_tr_b16 a[40:41], v4 offset:8192
  ds_read_b64_tr_b16 a[42:43], v4 offset:10240
  ds_read_b64_tr_b16 a[44:45], v5 offset:8192
  ds_read_b64_tr_b16 a[46:47], v5 offset:10240
  v_mul_f32 v230, v42, v36
  v_mul_f32 v246, v43, v36
  v_fma_f32 v230, v43, v45, v230
  v_fma_f32 v246, -v42, v45, v246
  v_fma_f32 v44, v40, v36, v231
  v_fma_f32 v37, v40, v45, v247
  v_fma_f32 v44, -v41, v45, v44
  v_fma_f32 v45, v41, v36, v37
  v_mul_f32 v231, v42, v44
  v_mul_f32 v247, v43, v44
  v_fma_f32 v231, v43, v45, v231
  buffer_load_dwordx4 v13, s[56:59], s78 offen offset:1024 lds
  v_fma_f32 v247, -v42, v45, v247
  v_fma_f32 v36, v40, v44, v232
  v_fma_f32 v37, v40, v45, v248
  v_fma_f32 v36, -v41, v45, v36
  v_fma_f32 v45, v41, v44, v37
  v_mul_f32 v232, v42, v36
  v_mul_f32 v248, v43, v36
  v_fma_f32 v232, v43, v45, v232
  v_fma_f32 v248, -v42, v45, v248
  v_fma_f32 v44, v40, v36, v233
  v_fma_f32 v37, v40, v45, v249
  s_waitcnt lgkmcnt(0)
  s_add_u32 m0, s84, 8192
  s_add_u32 s78, s78, 65536
  buffer_load_dwordx4 v6, s[56:59], s78 offen offset:0 lds
  v_fma_f32 v44, -v41, v45, v44
  v_fma_f32 v45, v41, v36, v37
  v_mul_f32 v233, v42, v44
  v_mul_f32 v249, v43, v44
  v_fma_f32 v233, v43, v45, v233
  v_fma_f32 v249, -v42, v45, v249
  v_fma_f32 v36, v40, v44, v234
  v_fma_f32 v37, v40, v45, v250
  v_fma_f32 v36, -v41, v45, v36
  v_fma_f32 v45, v41, v44, v37
  v_mul_f32 v234, v42, v36
  buffer_load_dwordx4 v13, s[56:59], s78 offen offset:1024 lds
  v_mul_f32 v250, v43, v36
  v_fma_f32 v234, v43, v45, v234
  v_fma_f32 v250, -v42, v45, v250
  v_fma_f32 v44, v40, v36, v235
  v_fma_f32 v37, v40, v45, v251
  v_fma_f32 v44, -v41, v45, v44
  v_fma_f32 v45, v41, v36, v37
  v_mul_f32 v235, v42, v44
  v_mul_f32 v251, v43, v44
  v_fma_f32 v235, v43, v45, v235
  v_fma_f32 v251, -v42, v45, v251
  s_add_u32 m0, s84, 10240
  s_add_u32 s78, s78, 65536
  buffer_load_dwordx4 v6, s[56:59], s78 offen offset:0 lds
  ds_read_b64_tr_b16 a[48:49], v2 offset:12288
  ds_read_b64_tr_b16 a[50:51], v2 offset:14336
  ds_read_b64_tr_b16 a[52:53], v3 offset:12288
  ds_read_b64_tr_b16 a[54:55], v3 offset:14336
  ds_read_b64_tr_b16 a[56:57], v4 offset:12288
  ds_read_b64_tr_b16 a[58:59], v4 offset:14336
  ds_read_b64_tr_b16 a[60:61], v5 offset:12288
  ds_read_b64_tr_b16 a[62:63], v5 offset:14336
  v_fma_f32 v36, v40, v44, v236
  v_fma_f32 v37, v40, v45, v252
  v_fma_f32 v36, -v41, v45, v36
  v_fma_f32 v45, v41, v44, v37
  v_mul_f32 v236, v42, v36
  v_mul_f32 v252, v43, v36
  v_fma_f32 v236, v43, v45, v236
  v_fma_f32 v252, -v42, v45, v252
  v_fma_f32 v44, v40, v36, v237
  v_fma_f32 v37, v40, v45, v253
  v_fma_f32 v44, -v41, v45, v44
  buffer_load_dwordx4 v13, s[56:59], s78 offen offset:1024 lds
  v_fma_f32 v45, v41, v36, v37
  v_mul_f32 v237, v42, v44
  v_mul_f32 v253, v43, v44
  v_fma_f32 v237, v43, v45, v237
  v_fma_f32 v253, -v42, v45, v253
  v_fma_f32 v36, v40, v44, v238
  v_fma_f32 v37, v40, v45, v254
  v_fma_f32 v36, -v41, v45, v36
  v_fma_f32 v45, v41, v44, v37
  v_mul_f32 v238, v42, v36
  v_mul_f32 v254, v43, v36
  s_waitcnt lgkmcnt(0)
  s_add_u32 m0, s84, 12288
  s_add_u32 s78, s78, 65536
  buffer_load_dwordx4 v6, s[56:59], s78 offen offset:0 lds
  v_fma_f32 v238, v43, v45, v238
  v_fma_f32 v254, -v42, v45, v254
  v_fma_f32 v44, v40, v36, v239
  v_fma_f32 v37, v40, v45, v255
  v_fma_f32 v44, -v41, v45, v44
  v_fma_f32 v45, v41, v36, v37
  v_mul_f32 v239, v42, v44
  v_mul_f32 v255, v43, v44
  v_fma_f32 v239, v43, v45, v239
  v_fma_f32 v255, -v42, v45, v255
  v_cvt_pk_bf16_f32 v224, v224, v225
  buffer_load_dwordx4 v13, s[56:59], s78 offen offset:1024 lds
  v_cvt_pk_bf16_f32 v240, v240, v241
  v_cvt_pk_bf16_f32 v225, v226, v227
  v_cvt_pk_bf16_f32 v241, v242, v243
  v_cvt_pk_bf16_f32 v226, v228, v229
  v_cvt_pk_bf16_f32 v242, v244, v245
  v_cvt_pk_bf16_f32 v227, v230, v231
  v_cvt_pk_bf16_f32 v243, v246, v247
  v_cvt_pk_bf16_f32 v228, v232, v233
  v_cvt_pk_bf16_f32 v244, v248, v249
  v_cvt_pk_bf16_f32 v229, v234, v235
  v_cvt_pk_bf16_f32 v245, v250, v251
  s_add_u32 m0, s84, 14336
  s_add_u32 s78, s78, 65536
  buffer_load_dwordx4 v6, s[56:59], s78 offen offset:0 lds
  ds_read_b64_tr_b16 a[64:65], v2 offset:16384
  ds_read_b64_tr_b16 a[66:67], v2 offset:18432
  ds_read_b64_tr_b16 a[68:69], v3 offset:16384
  ds_read_b64_tr_b16 a[70:71], v3 offset:18432
  ds_read_b64_tr_b16 a[72:73], v4 offset:16384
  ds_read_b64_tr_b16 a[74:75], v4 offset:18432
  ds_read_b64_tr_b16 a[76:77], v5 offset:16384
  ds_read_b64_tr_b16 a[78:79], v5 offset:18432
  v_cvt_pk_bf16_f32 v230, v236, v237
  v_cvt_pk_bf16_f32 v246, v252, v253
  v_cvt_pk_bf16_f32 v231, v238, v239
  v_cvt_pk_bf16_f32 v247, v254, v255
  v_and_b32 v8, 15, v0
  s_lshl_b32 s79, s66, 4
  v_add_u32 v8, s79, v8
  v_lshrrev_b32 v9, 3, v8
  v_lshlrev_b32 v9, 2, v9
  v_and_b32 v10, 3, v8
  v_add_u32 v9, v9, v10
  v_bfe_u32 v10, v8, 2, 1
  buffer_load_dwordx4 v13, s[56:59], s78 offen offset:1024 lds
  v_lshlrev_b32 v11, 4, v10
  v_add_u32 v9, v9, v11
  v_and_b32 v11, 7, v9
  v_lshlrev_b32 v10, 2, v10
  v_xor_b32 v11, v11, v10
  v_lshrrev_b32 v10, 4, v0
  v_lshlrev_b32 v10, 1, v10
  v_xor_b32 v10, v10, v11
  v_lshlrev_b32 v10, 4, v10
  v_lshlrev_b32 v9, 7, v9
  v_add_u32 v9, v9, v10
  s_waitcnt lgkmcnt(0)
  s_add_u32 m0, s84, 16384
  s_add_u32 s78, s78, 65536
  buffer_load_dwordx4 v6, s[56:59], s78 offen offset:0 lds
  s_lshl_b32 s79, s65, 12
  v_add_u32 v9, s79, v9
  v_xor_b32 v10, 16, v9
  s_barrier
  ds_write_b128 v9, v[224:227] offset:0
  ds_write_b128 v10, v[228:231] offset:0
  ds_write_b128 v9, v[240:243] offset:8192
  ds_write_b128 v10, v[244:247] offset:8192
  v_lshrrev_b32 v8, 2, v0
  v_and_b32 v9, 7, v8
  v_bfe_u32 v10, v0, 1, 1
  v_xor_b32 v9, v9, v10
  v_lshlrev_b32 v9, 4, v9
  buffer_load_dwordx4 v13, s[56:59], s78 offen offset:1024 lds
  v_lshlrev_b32 v8, 7, v8
  v_add_u32 v8, v8, v9
  v_and_b32 v9, 1, v0
  v_lshlrev_b32 v9, 3, v9
  v_add_u32 v8, v8, v9
  s_lshl_b32 s79, s64, 12
  v_add_u32 v8, s79, v8
  s_waitcnt lgkmcnt(0)
  s_barrier
  v_xor_b32 v9, 0, v8
  v_xor_b32 v10, 64, v9
  ds_read_b64_tr_b16 v[16:17], v9 offset:0
  ds_read_b64_tr_b16 v[18:19], v10 offset:2048
  v_xor_b32 v9, 32, v8
  s_add_u32 m0, s84, 18432
  s_add_u32 s78, s78, 65536
  buffer_load_dwordx4 v6, s[56:59], s78 offen offset:0 lds
  ds_read_b64_tr_b16 a[80:81], v2 offset:20480
  ds_read_b64_tr_b16 a[82:83], v2 offset:22528
  ds_read_b64_tr_b16 a[84:85], v3 offset:20480
  ds_read_b64_tr_b16 a[86:87], v3 offset:22528
  ds_read_b64_tr_b16 a[88:89], v4 offset:20480
  ds_read_b64_tr_b16 a[90:91], v4 offset:22528
  ds_read_b64_tr_b16 a[92:93], v5 offset:20480
  ds_read_b64_tr_b16 a[94:95], v5 offset:22528
  v_xor_b32 v10, 64, v9
  ds_read_b64_tr_b16 v[20:21], v9 offset:0
  ds_read_b64_tr_b16 v[22:23], v10 offset:2048
  v_xor_b32 v9, 64, v8
  v_xor_b32 v10, 64, v9
  ds_read_b64_tr_b16 v[24:25], v9 offset:0
  ds_read_b64_tr_b16 v[26:27], v10 offset:2048
  v_xor_b32 v9, 96, v8
  v_xor_b32 v10, 64, v9
  ds_read_b64_tr_b16 v[28:29], v9 offset:0
  ds_read_b64_tr_b16 v[30:31], v10 offset:2048
  buffer_load_dwordx4 v13, s[56:59], s78 offen offset:1024 lds
  s_mul_i32 s79, s67, 114688
  s_lshl_b32 s80, s68, 14
  s_add_u32 s79, s79, s80
  s_lshl_b32 s80, s64, 12
  s_add_u32 s79, s79, s80
  s_add_u32 s94, s79, 4194304
  s_waitcnt lgkmcnt(14)
  buffer_store_dwordx4 v[16:19], v1, s[44:47], s94 offen offset:0 sc1
  s_waitcnt lgkmcnt(4)
  buffer_store_dwordx4 v[20:23], v1, s[44:47], s94 offen offset:1024 sc1
  s_waitcnt lgkmcnt(2)
  buffer_store_dwordx4 v[24:27], v1, s[44:47], s94 offen offset:2048 sc1
  s_waitcnt lgkmcnt(0)
  buffer_store_dwordx4 v[28:31], v1, s[44:47], s94 offen offset:3072 sc1
  s_mov_b32 s60, s32
  s_and_b32 s61, s33, 0xffff
  s_mov_b32 s62, 3670016
  s_mov_b32 s63, 0x20000
  v_and_b32 v7, 15, v0
  v_lshrrev_b32 v8, 4, v0
  v_mul_u32_u24 v9, 896, v7
  v_lshlrev_b32 v10, 3, v8
  v_add_u32 v9, v9, v10
  s_lshl_b32 s79, s67, 6
  s_lshl_b32 s80, s66, 5
  s_add_u32 s79, s79, s80
  s_lshl_b32 s80, s68, 6
  s_lshl_b32 s81, s65, 5
  s_add_u32 s80, s80, s81
  v_lshrrev_b32 v9, 2, v7
  v_mul_u32_u24 v9, 26624, v9
  v_and_b32 v11, 3, v7
  v_lshlrev_b32 v11, 2, v11
  v_add_u32 v9, v9, v11
  s_lshl_b32 s81, s66, 5
  s_add_u32 s81, s81, 81920
  v_add_u32 v9, s81, v9
  ds_read_b32 v24, v9 offset:0
  ds_read_b32 v25, v9 offset:64
  ds_read_b32 v26, v9 offset:16
  ds_read_b32 v27, v9 offset:80
  s_lshl_b32 s81, s80, 1
  v_add_u32 v9, s81, v10
  global_load_dwordx2 v[28:29], v9, s[20:21]
  global_load_dwordx2 v[30:31], v9, s[20:21] offset:32
  v_add_u32 v9, s79, v7
  v_lshlrev_b32 v9, 1, v9
  global_load_ushort v10, v9, s[30:31]
  global_load_ushort v38, v9, s[30:31] offset:32
  s_add_u32 m0, s84, 20480
  s_add_u32 s78, s78, 65536
  buffer_load_dwordx4 v6, s[56:59], s78 offen offset:0 lds
  buffer_load_dwordx4 v13, s[56:59], s78 offen offset:1024 lds
  s_add_u32 m0, s84, 22528
  s_add_u32 s78, s78, 65536
  buffer_load_dwordx4 v6, s[56:59], s78 offen offset:0 lds
  ds_read_b64_tr_b16 a[96:97], v2 offset:0
  ds_read_b64_tr_b16 a[98:99], v2 offset:2048
  ds_read_b64_tr_b16 a[100:101], v3 offset:0
  ds_read_b64_tr_b16 a[102:103], v3 offset:2048
  ds_read_b64_tr_b16 a[104:105], v4 offset:0
  ds_read_b64_tr_b16 a[106:107], v4 offset:2048
  ds_read_b64_tr_b16 a[108:109], v5 offset:0
  ds_read_b64_tr_b16 a[110:111], v5 offset:2048
  buffer_load_dwordx4 v13, s[56:59], s78 offen offset:1024 lds
  s_waitcnt vmcnt(4) lgkmcnt(8)
  v_lshlrev_b32 v10, 16, v10
  v_lshlrev_b32 v38, 16, v38
  v_lshlrev_b32 v32, 16, v28
  v_and_b32 v33, s72, v28
  v_lshlrev_b32 v34, 16, v29
  v_and_b32 v35, s72, v29
  v_lshlrev_b32 v240, 16, v216
  v_and_b32 v241, s72, v216
  v_pk_add_f32 v[36:37], v[240:241], v[24:25] op_sel_hi:[1,0] neg_lo:[0,1] neg_hi:[0,1]
  v_pk_mul_f32 v[36:37], v[36:37], v[24:25] op_sel:[0,1] op_sel_hi:[1,1]
  v_pk_add_f32 v[240:241], v[240:241], v[10:11] op_sel_hi:[1,0]
  s_waitcnt lgkmcnt(0)
  s_add_u32 m0, s84, 0
  s_add_u32 s78, s78, 65536
  buffer_load_dwordx4 v6, s[56:59], s78 offen offset:0 lds
  v_pk_fma_f32 v[240:241], v[36:37], v[32:33], v[240:241]
  v_lshlrev_b32 v242, 16, v217
  v_and_b32 v243, s72, v217
  v_pk_add_f32 v[36:37], v[242:243], v[24:25] op_sel_hi:[1,0] neg_lo:[0,1] neg_hi:[0,1]
  v_pk_mul_f32 v[36:37], v[36:37], v[24:25] op_sel:[0,1] op_sel_hi:[1,1]
  v_pk_add_f32 v[242:243], v[242:243], v[10:11] op_sel_hi:[1,0]
  v_pk_fma_f32 v[242:243], v[36:37], v[34:35], v[242:243]
  v_lshlrev_b32 v248, 16, v220
  v_and_b32 v249, s72, v220
  v_pk_add_f32 v[36:37], v[248:249], v[26:27] op_sel_hi:[1,0] neg_lo:[0,1] neg_hi:[0,1]
  v_pk_mul_f32 v[36:37], v[36:37], v[26:27] op_sel:[0,1] op_sel_hi:[1,1]
  buffer_load_dwordx4 v13, s[56:59], s78 offen offset:1024 lds
  v_pk_add_f32 v[248:249], v[248:249], v[38:39] op_sel_hi:[1,0]
  v_pk_fma_f32 v[248:249], v[36:37], v[32:33], v[248:249]
  v_lshlrev_b32 v250, 16, v221
  v_and_b32 v251, s72, v221
  v_pk_add_f32 v[36:37], v[250:251], v[26:27] op_sel_hi:[1,0] neg_lo:[0,1] neg_hi:[0,1]
  v_pk_mul_f32 v[36:37], v[36:37], v[26:27] op_sel:[0,1] op_sel_hi:[1,1]
  v_pk_add_f32 v[250:251], v[250:251], v[38:39] op_sel_hi:[1,0]
  v_pk_fma_f32 v[250:251], v[36:37], v[34:35], v[250:251]
  v_lshlrev_b32 v32, 16, v30
  v_and_b32 v33, s72, v30
  v_lshlrev_b32 v34, 16, v31
  s_add_u32 m0, s84, 2048
  s_add_u32 s78, s78, 65536
  buffer_load_dwordx4 v6, s[56:59], s78 offen offset:0 lds
  ds_read_b64_tr_b16 a[112:113], v2 offset:4096
  ds_read_b64_tr_b16 a[114:115], v2 offset:6144
  ds_read_b64_tr_b16 a[116:117], v3 offset:4096
  ds_read_b64_tr_b16 a[118:119], v3 offset:6144
  ds_read_b64_tr_b16 a[120:121], v4 offset:4096
  ds_read_b64_tr_b16 a[122:123], v4 offset:6144
  ds_read_b64_tr_b16 a[124:125], v5 offset:4096
  ds_read_b64_tr_b16 a[126:127], v5 offset:6144
  v_and_b32 v35, s72, v31
  v_lshlrev_b32 v244, 16, v218
  v_and_b32 v245, s72, v218
  v_pk_add_f32 v[36:37], v[244:245], v[24:25] op_sel_hi:[1,0] neg_lo:[0,1] neg_hi:[0,1]
  v_pk_mul_f32 v[36:37], v[36:37], v[24:25] op_sel:[0,1] op_sel_hi:[1,1]
  v_pk_add_f32 v[244:245], v[244:245], v[10:11] op_sel_hi:[1,0]
  v_pk_fma_f32 v[244:245], v[36:37], v[32:33], v[244:245]
  v_lshlrev_b32 v246, 16, v219
  v_and_b32 v247, s72, v219
  v_pk_add_f32 v[36:37], v[246:247], v[24:25] op_sel_hi:[1,0] neg_lo:[0,1] neg_hi:[0,1]
  v_pk_mul_f32 v[36:37], v[36:37], v[24:25] op_sel:[0,1] op_sel_hi:[1,1]
  buffer_load_dwordx4 v13, s[56:59], s78 offen offset:1024 lds
  v_pk_add_f32 v[246:247], v[246:247], v[10:11] op_sel_hi:[1,0]
  v_pk_fma_f32 v[246:247], v[36:37], v[34:35], v[246:247]
  v_lshlrev_b32 v252, 16, v222
  v_and_b32 v253, s72, v222
  v_pk_add_f32 v[36:37], v[252:253], v[26:27] op_sel_hi:[1,0] neg_lo:[0,1] neg_hi:[0,1]
  v_pk_mul_f32 v[36:37], v[36:37], v[26:27] op_sel:[0,1] op_sel_hi:[1,1]
  v_pk_add_f32 v[252:253], v[252:253], v[38:39] op_sel_hi:[1,0]
  v_pk_fma_f32 v[252:253], v[36:37], v[32:33], v[252:253]
  v_lshlrev_b32 v254, 16, v223
  v_and_b32 v255, s72, v223
  v_pk_add_f32 v[36:37], v[254:255], v[26:27] op_sel_hi:[1,0] neg_lo:[0,1] neg_hi:[0,1]
  s_waitcnt lgkmcnt(0)
  s_add_u32 m0, s84, 4096
  s_add_u32 s78, s78, 65536
  buffer_load_dwordx4 v6, s[56:59], s78 offen offset:0 lds
  v_pk_mul_f32 v[36:37], v[36:37], v[26:27] op_sel:[0,1] op_sel_hi:[1,1]
  v_pk_add_f32 v[254:255], v[254:255], v[38:39] op_sel_hi:[1,0]
  v_pk_fma_f32 v[254:255], v[36:37], v[34:35], v[254:255]
  s_barrier
  s_cmp_lg_u32 s64, 0
  s_cbranch_scc1 L_flag_20
  s_mul_i32 s79, s67, 7
  s_add_u32 s79, s79, s68
  s_lshl_b32 s79, s79, 6
  s_add_u32 s79, s79, 1966080
  v_mov_b32 v8, 0
  v_mov_b32 v9, 1
  s_mov_b32 exec_lo, 1
  s_mov_b32 exec_hi, 0
  buffer_store_dword v9, v8, s[44:47], s79 offen sc1
  s_mov_b64 exec, -1
L_flag_20:
  s_add_u32 s91, s22, 0
  buffer_load_dwordx4 v[16:19], v1, s[44:47], s91 offen offset:0 sc1
  buffer_load_dwordx4 v13, s[56:59], s78 offen offset:1024 lds
  s_add_u32 s91, s22, 0
  buffer_load_dwordx4 v[20:23], v1, s[44:47], s91 offen offset:1024 sc1
  s_add_u32 m0, s84, 6144
  s_add_u32 s78, s78, 65536
  buffer_load_dwordx4 v6, s[56:59], s78 offen offset:0 lds
  ds_read_b64_tr_b16 a[128:129], v2 offset:8192
  ds_read_b64_tr_b16 a[130:131], v2 offset:10240
  ds_read_b64_tr_b16 a[132:133], v3 offset:8192
  ds_read_b64_tr_b16 a[134:135], v3 offset:10240
  ds_read_b64_tr_b16 a[136:137], v4 offset:8192
  ds_read_b64_tr_b16 a[138:139], v4 offset:10240
  ds_read_b64_tr_b16 a[140:141], v5 offset:8192
  ds_read_b64_tr_b16 a[142:143], v5 offset:10240
  s_add_u32 s91, s23, 0
  buffer_load_dwordx4 v[24:27], v1, s[44:47], s91 offen offset:0 sc1
  buffer_load_dwordx4 v13, s[56:59], s78 offen offset:1024 lds
  s_add_u32 s91, s23, 0
  buffer_load_dwordx4 v[28:31], v1, s[44:47], s91 offen offset:1024 sc1
  global_load_dword v11, v12, s[36:37] sc1
  ds_read_b64_tr_b16 a[144:145], v2 offset:12288
  ds_read_b64_tr_b16 a[146:147], v2 offset:14336
  ds_read_b64_tr_b16 a[148:149], v3 offset:12288
  ds_read_b64_tr_b16 a[150:151], v3 offset:14336
  ds_read_b64_tr_b16 a[152:153], v4 offset:12288
  ds_read_b64_tr_b16 a[154:155], v4 offset:14336
  ds_read_b64_tr_b16 a[156:157], v5 offset:12288
  ds_read_b64_tr_b16 a[158:159], v5 offset:14336
  s_add_u32 s91, s22, 4096
  buffer_load_dwordx4 v[32:35], v1, s[44:47], s91 offen offset:0 sc1
  ds_read_b64_tr_b16 a[160:161], v2 offset:16384
  ds_read_b64_tr_b16 a[162:163], v2 offset:18432
  ds_read_b64_tr_b16 a[164:165], v3 offset:16384
  ds_read_b64_tr_b16 a[166:167], v3 offset:18432
  ds_read_b64_tr_b16 a[168:169], v4 offset:16384
  ds_read_b64_tr_b16 a[170:171], v4 offset:18432
  ds_read_b64_tr_b16 a[172:173], v5 offset:16384
  ds_read_b64_tr_b16 a[174:175], v5 offset:18432
  s_add_u32 s91, s22, 4096
  buffer_load_dwordx4 v[36:39], v1, s[44:47], s91 offen offset:1024 sc1
  s_waitcnt vmcnt(15)
  ds_read_b64_tr_b16 a[176:177], v2 offset:20480
  ds_read_b64_tr_b16 a[178:179], v2 offset:22528
  ds_read_b64_tr_b16 a[180:181], v3 offset:20480
  ds_read_b64_tr_b16 a[182:183], v3 offset:22528
  ds_read_b64_tr_b16 a[184:185], v4 offset:20480
  ds_read_b64_tr_b16 a[186:187], v4 offset:22528
  ds_read_b64_tr_b16 a[188:189], v5 offset:20480
  ds_read_b64_tr_b16 a[190:191], v5 offset:22528
  s_add_u32 s91, s23, 4096
  buffer_load_dwordx4 v[40:43], v1, s[44:47], s91 offen offset:0 sc1
  s_waitcnt vmcnt(12)
  ds_read_b64_tr_b16 a[192:193], v2 offset:0
  ds_read_b64_tr_b16 a[194:195], v2 offset:2048
  ds_read_b64_tr_b16 a[196:197], v3 offset:0
  ds_read_b64_tr_b16 a[198:199], v3 offset:2048
  ds_read_b64_tr_b16 a[200:201], v4 offset:0
  ds_read_b64_tr_b16 a[202:203], v4 offset:2048
  ds_read_b64_tr_b16 a[204:205], v5 offset:0
  ds_read_b64_tr_b16 a[206:207], v5 offset:2048
  s_add_u32 s91, s23, 4096
  buffer_load_dwordx4 v[44:47], v1, s[44:47], s91 offen offset:1024 sc1
  s_waitcnt vmcnt(6)
  ds_read_b64_tr_b16 a[208:209], v2 offset:4096
  ds_read_b64_tr_b16 a[210:211], v2 offset:6144
  ds_read_b64_tr_b16 a[212:213], v3 offset:4096
  ds_read_b64_tr_b16 a[214:215], v3 offset:6144
  ds_read_b64_tr_b16 a[216:217], v4 offset:4096
  ds_read_b64_tr_b16 a[218:219], v4 offset:6144
  ds_read_b64_tr_b16 a[220:221], v5 offset:4096
  ds_read_b64_tr_b16 a[222:223], v5 offset:6144
  s_add_u32 s91, s22, 8192
  buffer_load_dwordx4 v[48:51], v1, s[44:47], s91 offen offset:0 sc1
  s_add_u32 s91, s22, 8192
  buffer_load_dwordx4 v[52:55], v1, s[44:47], s91 offen offset:1024 sc1
  s_add_u32 s91, s23, 8192
  buffer_load_dwordx4 v[216:219], v1, s[44:47], s91 offen offset:0 sc1
  s_add_u32 s91, s23, 8192
  buffer_load_dwordx4 v[220:223], v1, s[44:47], s91 offen offset:1024 sc1
  s_add_u32 s91, s22, 12288
  buffer_load_dwordx4 v[224:227], v1, s[44:47], s91 offen offset:0 sc1
  s_add_u32 s91, s22, 12288
  buffer_load_dwordx4 v[228:231], v1, s[44:47], s91 offen offset:1024 sc1
  s_add_u32 s91, s23, 12288
  buffer_load_dwordx4 v[232:235], v1, s[44:47], s91 offen offset:0 sc1
  s_add_u32 s91, s23, 12288
  buffer_load_dwordx4 v[236:239], v1, s[44:47], s91 offen offset:1024 sc1
  s_waitcnt lgkmcnt(0)
  s_waitcnt vmcnt(12)
  v_cmp_gt_u32 vcc, 1, v11
  s_cbranch_vccz L_fwd_22
  s_mov_b32 s83, 0x40000
L_fw_21:
  global_load_dword v11, v12, s[36:37] sc1
  s_waitcnt vmcnt(0)
  v_cmp_gt_u32 vcc, 1, v11
  s_cbranch_vccz L_fwd_22
  s_sleep 4
  s_sub_u32 s83, s83, 1
  s_cbranch_scc0 L_fw_21
L_fwd_22:
  buffer_load_dwordx4 v[120:123], v1, s[44:47], s90 offen offset:0 sc1
  buffer_load_dwordx4 v[124:127], v1, s[44:47], s90 offen offset:1024 sc1
  s_add_u32 s90, s90, 4096
  buffer_load_dwordx4 v[128:131], v1, s[44:47], s92 offen offset:0 sc1
  buffer_load_dwordx4 v[132:135], v1, s[44:47], s92 offen offset:1024 sc1
  s_add_u32 s92, s92, 4096
  buffer_load_dwordx4 v[136:139], v1, s[44:47], s90 offen offset:0 sc1
  buffer_load_dwordx4 v[140:143], v1, s[44:47], s90 offen offset:1024 sc1
  s_add_u32 s90, s90, 4096
  buffer_load_dwordx4 v[144:147], v1, s[44:47], s92 offen offset:0 sc1
  buffer_load_dwordx4 v[148:151], v1, s[44:47], s92 offen offset:1024 sc1
  s_add_u32 s92, s92, 4096
  buffer_load_dwordx4 v[152:155], v1, s[44:47], s90 offen offset:0 sc1
  buffer_load_dwordx4 v[156:159], v1, s[44:47], s90 offen offset:1024 sc1
  s_add_u32 s90, s90, 4096
  buffer_load_dwordx4 v[160:163], v1, s[44:47], s92 offen offset:0 sc1
  buffer_load_dwordx4 v[164:167], v1, s[44:47], s92 offen offset:1024 sc1
  s_add_u32 s92, s92, 4096
  buffer_load_dwordx4 v[168:171], v1, s[44:47], s90 offen offset:0 sc1
  buffer_load_dwordx4 v[172:175], v1, s[44:47], s90 offen offset:1024 sc1
  s_add_u32 s90, s90, 4096
  buffer_load_dwordx4 v[176:179], v1, s[44:47], s92 offen offset:0 sc1
  buffer_load_dwordx4 v[180:183], v1, s[44:47], s92 offen offset:1024 sc1
  s_add_u32 s92, s92, 4096
  buffer_load_dwordx4 v[184:187], v1, s[44:47], s90 offen offset:0 sc1
  buffer_load_dwordx4 v[188:191], v1, s[44:47], s90 offen offset:1024 sc1
  s_add_u32 s90, s90, 4096
  buffer_load_dwordx4 v[192:195], v1, s[44:47], s92 offen offset:0 sc1
  buffer_load_dwordx4 v[196:199], v1, s[44:47], s92 offen offset:1024 sc1
  s_add_u32 s92, s92, 4096
  buffer_load_dwordx4 v[200:203], v1, s[44:47], s90 offen offset:0 sc1
  buffer_load_dwordx4 v[204:207], v1, s[44:47], s90 offen offset:1024 sc1
  s_add_u32 s90, s90, 4096
  buffer_load_dwordx4 v[208:211], v1, s[44:47], s92 offen offset:0 sc1
  buffer_load_dwordx4 v[212:215], v1, s[44:47], s92 offen offset:1024 sc1
  s_add_u32 s92, s92, 4096
  s_waitcnt vmcnt(23)
  v_mfma_f32_16x16x32_bf16 v[56:59], v[120:123], a[0:3], 0
  v_mfma_f32_16x16x32_bf16 v[60:63], v[120:123], a[4:7], 0
  v_mfma_f32_16x16x32_bf16 v[64:67], v[120:123], a[8:11], 0
  v_mfma_f32_16x16x32_bf16 v[68:71], v[120:123], a[12:15], 0
  buffer_load_dwordx4 v[120:123], v1, s[44:47], s90 offen offset:0 sc1
  s_waitcnt vmcnt(23)
  v_mfma_f32_16x16x32_bf16 v[72:75], v[124:127], a[0:3], 0
  v_mfma_f32_16x16x32_bf16 v[76:79], v[124:127], a[4:7], 0
  v_mfma_f32_16x16x32_bf16 v[80:83], v[124:127], a[8:11], 0
  v_mfma_f32_16x16x32_bf16 v[84:87], v[124:127], a[12:15], 0
  buffer_load_dwordx4 v[124:127], v1, s[44:47], s90 offen offset:1024 sc1
  s_add_u32 s90, s90, 4096
  s_waitcnt vmcnt(23)
  v_mfma_f32_16x16x32_bf16 v[88:91], v[128:131], a[0:3], 0
  v_mfma_f32_16x16x32_bf16 v[92:95], v[128:131], a[4:7], 0
  v_mfma_f32_16x16x32_bf16 v[96:99], v[128:131], a[8:11], 0
  v_mfma_f32_16x16x32_bf16 v[100:103], v[128:131], a[12:15], 0
  buffer_load_dwordx4 v[128:131], v1, s[44:47], s92 offen offset:0 sc1
  s_waitcnt vmcnt(23)
  v_mfma_f32_16x16x32_bf16 v[104:107], v[132:135], a[0:3], 0
  v_mfma_f32_16x16x32_bf16 v[108:111], v[132:135], a[4:7], 0
  v_mfma_f32_16x16x32_bf16 v[112:115], v[132:135], a[8:11], 0
  v_mfma_f32_16x16x32_bf16 v[116:119], v[132:135], a[12:15], 0
  buffer_load_dwordx4 v[132:135], v1, s[44:47], s92 offen offset:1024 sc1
  s_add_u32 s92, s92, 4096
  s_waitcnt vmcnt(23)
  v_mfma_f32_16x16x32_bf16 v[56:59], v[136:139], a[16:19], v[56:59]
  v_mfma_f32_16x16x32_bf16 v[60:63], v[136:139], a[20:23], v[60:63]
  v_mfma_f32_16x16x32_bf16 v[64:67], v[136:139], a[24:27], v[64:67]
  v_mfma_f32_16x16x32_bf16 v[68:71], v[136:139], a[28:31], v[68:71]
  buffer_load_dwordx4 v[136:139], v1, s[44:47], s90 offen offset:0 sc1
  s_add_u32 s91, s22, 16384
  buffer_load_dwordx4 a[0:3], v1, s[44:47], s91 offen offset:0 sc1
  s_waitcnt vmcnt(24)
  v_mfma_f32_16x16x32_bf16 v[72:75], v[140:143], a[16:19], v[72:75]
  v_mfma_f32_16x16x32_bf16 v[76:79], v[140:143], a[20:23], v[76:79]
  v_mfma_f32_16x16x32_bf16 v[80:83], v[140:143], a[24:27], v[80:83]
  v_mfma_f32_16x16x32_bf16 v[84:87], v[140:143], a[28:31], v[84:87]
  buffer_load_dwordx4 v[140:143], v1, s[44:47], s90 offen offset:1024 sc1
  s_add_u32 s90, s90, 4096
  s_add_u32 s91, s22, 16384
  buffer_load_dwordx4 a[4:7], v1, s[44:47], s91 offen offset:1024 sc1
  s_waitcnt vmcnt(25)
  v_mfma_f32_16x16x32_bf16 v[88:91], v[144:147], a[16:19], v[88:91]
  v_mfma_f32_16x16x32_bf16 v[92:95], v[144:147], a[20:23], v[92:95]
  v_mfma_f32_16x16x32_bf16 v[96:99], v[144:147], a[24:27], v[96:99]
  v_mfma_f32_16x16x32_bf16 v[100:103], v[144:147], a[28:31], v[100:103]
  buffer_load_dwordx4 v[144:147], v1, s[44:47], s92 offen offset:0 sc1
  s_add_u32 s91, s23, 16384
  buffer_load_dwordx4 a[8:11], v1, s[44:47], s91 offen offset:0 sc1
  s_waitcnt vmcnt(26)
  v_mfma_f32_16x16x32_bf16 v[104:107], v[148:151], a[16:19], v[104:107]
  v_mfma_f32_16x16x32_bf16 v[108:111], v[148:151], a[20:23], v[108:111]
  v_mfma_f32_16x16x32_bf16 v[112:115], v[148:151], a[24:27], v[112:115]
  v_mfma_f32_16x16x32_bf16 v[116:119], v[148:151], a[28:31], v[116:119]
  buffer_load_dwordx4 v[148:151], v1, s[44:47], s92 offen offset:1024 sc1
  s_add_u32 s92, s92, 4096
  s_add_u32 s91, s23, 16384
  buffer_load_dwordx4 a[12:15], v1, s[44:47], s91 offen offset:1024 sc1
  s_waitcnt vmcnt(27)
  v_mfma_f32_16x16x32_bf16 v[56:59], v[152:155], a[32:35], v[56:59]
  v_mfma_f32_16x16x32_bf16 v[60:63], v[152:155], a[36:39], v[60:63]
  v_mfma_f32_16x16x32_bf16 v[64:67], v[152:155], a[40:43], v[64:67]
  v_mfma_f32_16x16x32_bf16 v[68:71], v[152:155], a[44:47], v[68:71]
  buffer_load_dwordx4 v[152:155], v1, s[44:47], s90 offen offset:0 sc1
  s_waitcnt vmcnt(27)
  v_mfma_f32_16x16x32_bf16 v[72:75], v[156:159], a[32:35], v[72:75]
  v_mfma_f32_16x16x32_bf16 v[76:79], v[156:159], a[36:39], v[76:79]
  v_mfma_f32_16x16x32_bf16 v[80:83], v[156:159], a[40:43], v[80:83]
  v_mfma_f32_16x16x32_bf16 v[84:87], v[156:159], a[44:47], v[84:87]
  buffer_load_dwordx4 v[156:159], v1, s[44:47], s90 offen offset:1024 sc1
  s_add_u32 s90, s90, 4096
  s_waitcnt vmcnt(27)
  v_mfma_f32_16x16x32_bf16 v[88:91], v[160:163], a[32:35], v[88:91]
  v_mfma_f32_16x16x32_bf16 v[92:95], v[160:163], a[36:39], v[92:95]
  v_mfma_f32_16x16x32_bf16 v[96:99], v[160:163], a[40:43], v[96:99]
  v_mfma_f32_16x16x32_bf16 v[100:103], v[160:163], a[44:47], v[100:103]
  buffer_load_dwordx4 v[160:163], v1, s[44:47], s92 offen offset:0 sc1
  s_waitcnt vmcnt(27)
  v_mfma_f32_16x16x32_bf16 v[104:107], v[164:167], a[32:35], v[104:107]
  v_mfma_f32_16x16x32_bf16 v[108:111], v[164:167], a[36:39], v[108:111]
  v_mfma_f32_16x16x32_bf16 v[112:115], v[164:167], a[40:43], v[112:115]
  v_mfma_f32_16x16x32_bf16 v[116:119], v[164:167], a[44:47], v[116:119]
  buffer_load_dwordx4 v[164:167], v1, s[44:47], s92 offen offset:1024 sc1
  s_add_u32 s92, s92, 4096
  global_load_dword v11, v14, s[36:37] sc1
  s_waitcnt vmcnt(28)
  v_mfma_f32_16x16x32_bf16 v[56:59], v[168:171], a[48:51], v[56:59]
  v_mfma_f32_16x16x32_bf16 v[60:63], v[168:171], a[52:55], v[60:63]
  v_mfma_f32_16x16x32_bf16 v[64:67], v[168:171], a[56:59], v[64:67]
  v_mfma_f32_16x16x32_bf16 v[68:71], v[168:171], a[60:63], v[68:71]
  buffer_load_dwordx4 v[168:171], v1, s[44:47], s90 offen offset:0 sc1
  s_waitcnt vmcnt(28)
  v_mfma_f32_16x16x32_bf16 v[72:75], v[172:175], a[48:51], v[72:75]
  v_mfma_f32_16x16x32_bf16 v[76:79], v[172:175], a[52:55], v[76:79]
  v_mfma_f32_16x16x32_bf16 v[80:83], v[172:175], a[56:59], v[80:83]
  v_mfma_f32_16x16x32_bf16 v[84:87], v[172:175], a[60:63], v[84:87]
  buffer_load_dwordx4 v[172:175], v1, s[44:47], s90 offen offset:1024 sc1
  s_add_u32 s90, s90, 4096
  s_waitcnt vmcnt(28)
  v_mfma_f32_16x16x32_bf16 v[88:91], v[176:179], a[48:51], v[88:91]
  v_mfma_f32_16x16x32_bf16 v[92:95], v[176:179], a[52:55], v[92:95]
  v_mfma_f32_16x16x32_bf16 v[96:99], v[176:179], a[56:59], v[96:99]
  v_mfma_f32_16x16x32_bf16 v[100:103], v[176:179], a[60:63], v[100:103]
  buffer_load_dwordx4 v[176:179], v1, s[44:47], s92 offen offset:0 sc1
  s_waitcnt vmcnt(28)
  v_mfma_f32_16x16x32_bf16 v[104:107], v[180:183], a[48:51], v[104:107]
  v_mfma_f32_16x16x32_bf16 v[108:111], v[180:183], a[52:55], v[108:111]
  v_mfma_f32_16x16x32_bf16 v[112:115], v[180:183], a[56:59], v[112:115]
  v_mfma_f32_16x16x32_bf16 v[116:119], v[180:183], a[60:63], v[116:119]
  buffer_load_dwordx4 v[180:183], v1, s[44:47], s92 offen offset:1024 sc1
  s_add_u32 s92, s92, 4096
  s_waitcnt vmcnt(28)
  v_mfma_f32_16x16x32_bf16 v[56:59], v[184:187], a[64:67], v[56:59]
  v_mfma_f32_16x16x32_bf16 v[60:63], v[184:187], a[68:71], v[60:63]
  v_mfma_f32_16x16x32_bf16 v[64:67], v[184:187], a[72:75], v[64:67]
  v_mfma_f32_16x16x32_bf16 v[68:71], v[184:187], a[76:79], v[68:71]
  buffer_load_dwordx4 v[184:187], v1, s[44:47], s90 offen offset:0 sc1
  s_waitcnt vmcnt(28)
  v_mfma_f32_16x16x32_bf16 v[72:75], v[188:191], a[64:67], v[72:75]
  v_mfma_f32_16x16x32_bf16 v[76:79], v[188:191], a[68:71], v[76:79]
  v_mfma_f32_16x16x32_bf16 v[80:83], v[188:191], a[72:75], v[80:83]
  v_mfma_f32_16x16x32_bf16 v[84:87], v[188:191], a[76:79], v[84:87]
  buffer_load_dwordx4 v[188:191], v1, s[44:47], s90 offen offset:1024 sc1
  s_add_u32 s90, s90, 4096
  s_waitcnt vmcnt(28)
  v_mfma_f32_16x16x32_bf16 v[88:91], v[192:195], a[64:67], v[88:91]
  v_mfma_f32_16x16x32_bf16 v[92:95], v[192:195], a[68:71], v[92:95]
  v_mfma_f32_16x16x32_bf16 v[96:99], v[192:195], a[72:75], v[96:99]
  v_mfma_f32_16x16x32_bf16 v[100:103], v[192:195], a[76:79], v[100:103]
  buffer_load_dwordx4 v[192:195], v1, s[44:47], s92 offen offset:0 sc1
  s_waitcnt vmcnt(28)
  v_mfma_f32_16x16x32_bf16 v[104:107], v[196:199], a[64:67], v[104:107]
  v_mfma_f32_16x16x32_bf16 v[108:111], v[196:199], a[68:71], v[108:111]
  v_mfma_f32_16x16x32_bf16 v[112:115], v[196:199], a[72:75], v[112:115]
  v_mfma_f32_16x16x32_bf16 v[116:119], v[196:199], a[76:79], v[116:119]
  buffer_load_dwordx4 v[196:199], v1, s[44:47], s92 offen offset:1024 sc1
  s_add_u32 s92, s92, 4096
  s_waitcnt vmcnt(28)
  v_mfma_f32_16x16x32_bf16 v[56:59], v[200:203], a[80:83], v[56:59]
  v_mfma_f32_16x16x32_bf16 v[60:63], v[200:203], a[84:87], v[60:63]
  v_mfma_f32_16x16x32_bf16 v[64:67], v[200:203], a[88:91], v[64:67]
  v_mfma_f32_16x16x32_bf16 v[68:71], v[200:203], a[92:95], v[68:71]
  buffer_load_dwordx4 v[200:203], v1, s[44:47], s90 offen offset:0 sc1
  s_waitcnt vmcnt(28)
  v_mfma_f32_16x16x32_bf16 v[72:75], v[204:207], a[80:83], v[72:75]
  v_mfma_f32_16x16x32_bf16 v[76:79], v[204:207], a[84:87], v[76:79]
  v_mfma_f32_16x16x32_bf16 v[80:83], v[204:207], a[88:91], v[80:83]
  v_mfma_f32_16x16x32_bf16 v[84:87], v[204:207], a[92:95], v[84:87]
  buffer_load_dwordx4 v[204:207], v1, s[44:47], s90 offen offset:1024 sc1
  s_add_u32 s90, s90, 4096
  s_waitcnt vmcnt(28)
  v_mfma_f32_16x16x32_bf16 v[88:91], v[208:211], a[80:83], v[88:91]
  v_mfma_f32_16x16x32_bf16 v[92:95], v[208:211], a[84:87], v[92:95]
  v_mfma_f32_16x16x32_bf16 v[96:99], v[208:211], a[88:91], v[96:99]
  v_mfma_f32_16x16x32_bf16 v[100:103], v[208:211], a[92:95], v[100:103]
  buffer_load_dwordx4 v[208:211], v1, s[44:47], s92 offen offset:0 sc1
  s_waitcnt vmcnt(28)
  v_mfma_f32_16x16x32_bf16 v[104:107], v[212:215], a[80:83], v[104:107]
  v_mfma_f32_16x16x32_bf16 v[108:111], v[212:215], a[84:87], v[108:111]
  v_mfma_f32_16x16x32_bf16 v[112:115], v[212:215], a[88:91], v[112:115]
  v_mfma_f32_16x16x32_bf16 v[116:119], v[212:215], a[92:95], v[116:119]
  buffer_load_dwordx4 v[212:215], v1, s[44:47], s92 offen offset:1024 sc1
  s_add_u32 s92, s92, 4096
  s_waitcnt vmcnt(28)
  v_mfma_f32_16x16x32_bf16 v[56:59], v[120:123], a[96:99], v[56:59]
  v_mfma_f32_16x16x32_bf16 v[60:63], v[120:123], a[100:103], v[60:63]
  v_mfma_f32_16x16x32_bf16 v[64:67], v[120:123], a[104:107], v[64:67]
  v_mfma_f32_16x16x32_bf16 v[68:71], v[120:123], a[108:111], v[68:71]
  buffer_load_dwordx4 v[120:123], v1, s[44:47], s90 offen offset:0 sc1
  s_waitcnt vmcnt(28)
  v_mfma_f32_16x16x32_bf16 v[72:75], v[124:127], a[96:99], v[72:75]
  v_mfma_f32_16x16x32_bf16 v[76:79], v[124:127], a[100:103], v[76:79]
  v_mfma_f32_16x16x32_bf16 v[80:83], v[124:127], a[104:107], v[80:83]
  v_mfma_f32_16x16x32_bf16 v[84:87], v[124:127], a[108:111], v[84:87]
  buffer_load_dwordx4 v[124:127], v1, s[44:47], s90 offen offset:1024 sc1
  s_add_u32 s90, s90, 4096
  s_waitcnt vmcnt(28)
  v_mfma_f32_16x16x32_bf16 v[88:91], v[128:131], a[96:99], v[88:91]
  v_mfma_f32_16x16x32_bf16 v[92:95], v[128:131], a[100:103], v[92:95]
  v_mfma_f32_16x16x32_bf16 v[96:99], v[128:131], a[104:107], v[96:99]
  v_mfma_f32_16x16x32_bf16 v[100:103], v[128:131], a[108:111], v[100:103]
  buffer_load_dwordx4 v[128:131], v1, s[44:47], s92 offen offset:0 sc1
  s_waitcnt vmcnt(28)
  v_mfma_f32_16x16x32_bf16 v[104:107], v[132:135], a[96:99], v[104:107]
  v_mfma_f32_16x16x32_bf16 v[108:111], v[132:135], a[100:103], v[108:111]
  v_mfma_f32_16x16x32_bf16 v[112:115], v[132:135], a[104:107], v[112:115]
  v_mfma_f32_16x16x32_bf16 v[116:119], v[132:135], a[108:111], v[116:119]
  buffer_load_dwordx4 v[132:135], v1, s[44:47], s92 offen offset:1024 sc1
  s_add_u32 s92, s92, 4096
  s_waitcnt vmcnt(28)
  v_mfma_f32_16x16x32_bf16 v[56:59], v[136:139], a[112:115], v[56:59]
  v_mfma_f32_16x16x32_bf16 v[60:63], v[136:139], a[116:119], v[60:63]
  v_mfma_f32_16x16x32_bf16 v[64:67], v[136:139], a[120:123], v[64:67]
  v_mfma_f32_16x16x32_bf16 v[68:71], v[136:139], a[124:127], v[68:71]
  buffer_load_dwordx4 v[136:139], v1, s[44:47], s90 offen offset:0 sc1
  s_waitcnt vmcnt(27)
  v_mfma_f32_16x16x32_bf16 v[72:75], v[140:143], a[112:115], v[72:75]
  v_mfma_f32_16x16x32_bf16 v[76:79], v[140:143], a[116:119], v[76:79]
  v_mfma_f32_16x16x32_bf16 v[80:83], v[140:143], a[120:123], v[80:83]
  v_mfma_f32_16x16x32_bf16 v[84:87], v[140:143], a[124:127], v[84:87]
  buffer_load_dwordx4 v[140:143], v1, s[44:47], s90 offen offset:1024 sc1
  s_waitcnt vmcnt(26)
  v_mfma_f32_16x16x32_bf16 v[88:91], v[144:147], a[112:115], v[88:91]
  v_mfma_f32_16x16x32_bf16 v[92:95], v[144:147], a[116:119], v[92:95]
  v_mfma_f32_16x16x32_bf16 v[96:99], v[144:147], a[120:123], v[96:99]
  v_mfma_f32_16x16x32_bf16 v[100:103], v[144:147], a[124:127], v[100:103]
  buffer_load_dwordx4 v[144:147], v1, s[44:47], s92 offen offset:0 sc1
  s_waitcnt vmcnt(25)
  v_mfma_f32_16x16x32_bf16 v[104:107], v[148:151], a[112:115], v[104:107]
  v_mfma_f32_16x16x32_bf16 v[108:111], v[148:151], a[116:119], v[108:111]
  v_mfma_f32_16x16x32_bf16 v[112:115], v[148:151], a[120:123], v[112:115]
  v_mfma_f32_16x16x32_bf16 v[116:119], v[148:151], a[124:127], v[116:119]
  buffer_load_dwordx4 v[148:151], v1, s[44:47], s92 offen offset:1024 sc1
  s_waitcnt vmcnt(24)
  v_mfma_f32_16x16x32_bf16 v[56:59], v[152:155], a[128:131], v[56:59]
  v_mfma_f32_16x16x32_bf16 v[60:63], v[152:155], a[132:135], v[60:63]
  v_mfma_f32_16x16x32_bf16 v[64:67], v[152:155], a[136:139], v[64:67]
  v_mfma_f32_16x16x32_bf16 v[68:71], v[152:155], a[140:143], v[68:71]
  s_waitcnt vmcnt(20)
  v_cmp_gt_u32 vcc, 1, v11
  s_cbranch_vccz L_fwd_24
  s_mov_b32 s83, 0x40000
L_fw_23:
  global_load_dword v11, v14, s[36:37] sc1
  s_waitcnt vmcnt(0)
  v_cmp_gt_u32 vcc, 1, v11
  s_cbranch_vccz L_fwd_24
  s_sleep 4
  s_sub_u32 s83, s83, 1
  s_cbranch_scc0 L_fw_23
L_fwd_24:
  buffer_load_dwordx4 v[152:155], v1, s[44:47], s38 offen offset:0 sc1
  v_mfma_f32_16x16x32_bf16 v[72:75], v[156:159], a[128:131], v[72:75]
  v_mfma_f32_16x16x32_bf16 v[76:79], v[156:159], a[132:135], v[76:79]
  v_mfma_f32_16x16x32_bf16 v[80:83], v[156:159], a[136:139], v[80:83]
  v_mfma_f32_16x16x32_bf16 v[84:87], v[156:159], a[140:143], v[84:87]
  buffer_load_dwordx4 v[156:159], v1, s[44:47], s38 offen offset:1024 sc1
  s_add_u32 s38, s38, 4096
  v_mfma_f32_16x16x32_bf16 v[88:91], v[160:163], a[128:131], v[88:91]
  v_mfma_f32_16x16x32_bf16 v[92:95], v[160:163], a[132:135], v[92:95]
  v_mfma_f32_16x16x32_bf16 v[96:99], v[160:163], a[136:139], v[96:99]
  v_mfma_f32_16x16x32_bf16 v[100:103], v[160:163], a[140:143], v[100:103]
  buffer_load_dwordx4 v[160:163], v1, s[44:47], s39 offen offset:0 sc1
  v_mfma_f32_16x16x32_bf16 v[104:107], v[164:167], a[128:131], v[104:107]
  v_mfma_f32_16x16x32_bf16 v[108:111], v[164:167], a[132:135], v[108:111]
  v_mfma_f32_16x16x32_bf16 v[112:115], v[164:167], a[136:139], v[112:115]
  v_mfma_f32_16x16x32_bf16 v[116:119], v[164:167], a[140:143], v[116:119]
  buffer_load_dwordx4 v[164:167], v1, s[44:47], s39 offen offset:1024 sc1
  s_add_u32 s39, s39, 4096
  s_waitcnt vmcnt(23)
  v_mfma_f32_16x16x32_bf16 v[56:59], v[168:171], a[144:147], v[56:59]
  v_mfma_f32_16x16x32_bf16 v[60:63], v[168:171], a[148:151], v[60:63]
  v_mfma_f32_16x16x32_bf16 v[64:67], v[168:171], a[152:155], v[64:67]
  v_mfma_f32_16x16x32_bf16 v[68:71], v[168:171], a[156:159], v[68:71]
  buffer_load_dwordx4 v[168:171], v1, s[44:47], s38 offen offset:0 sc1
  s_waitcnt vmcnt(23)
  v_mfma_f32_16x16x32_bf16 v[72:75], v[172:175], a[144:147], v[72:75]
  v_mfma_f32_16x16x32_bf16 v[76:79], v[172:175], a[148:151], v[76:79]
  v_mfma_f32_16x16x32_bf16 v[80:83], v[172:175], a[152:155], v[80:83]
  v_mfma_f32_16x16x32_bf16 v[84:87], v[172:175], a[156:159], v[84:87]
  buffer_load_dwordx4 v[172:175], v1, s[44:47], s38 offen offset:1024 sc1
  s_add_u32 s38, s38, 4096
  s_waitcnt vmcnt(23)
  v_mfma_f32_16x16x32_bf16 v[88:91], v[176:179], a[144:147], v[88:91]
  v_mfma_f32_16x16x32_bf16 v[92:95], v[176:179], a[148:151], v[92:95]
  v_mfma_f32_16x16x32_bf16 v[96:99], v[176:179], a[152:155], v[96:99]
  v_mfma_f32_16x16x32_bf16 v[100:103], v[176:179], a[156:159], v[100:103]
  buffer_load_dwordx4 v[176:179], v1, s[44:47], s39 offen offset:0 sc1
  s_waitcnt vmcnt(23)
  v_mfma_f32_16x16x32_bf16 v[104:107], v[180:183], a[144:147], v[104:107]
  v_mfma_f32_16x16x32_bf16 v[108:111], v[180:183], a[148:151], v[108:111]
  v_mfma_f32_16x16x32_bf16 v[112:115], v[180:183], a[152:155], v[112:115]
  v_mfma_f32_16x16x32_bf16 v[116:119], v[180:183], a[156:159], v[116:119]
  buffer_load_dwordx4 v[180:183], v1, s[44:47], s39 offen offset:1024 sc1
  s_add_u32 s39, s39, 4096
  s_waitcnt vmcnt(23)
  v_mfma_f32_16x16x32_bf16 v[56:59], v[184:187], a[160:163], v[56:59]
  v_mfma_f32_16x16x32_bf16 v[60:63], v[184:187], a[164:167], v[60:63]
  v_mfma_f32_16x16x32_bf16 v[64:67], v[184:187], a[168:171], v[64:67]
  v_mfma_f32_16x16x32_bf16 v[68:71], v[184:187], a[172:175], v[68:71]
  buffer_load_dwordx4 v[184:187], v1, s[44:47], s38 offen offset:0 sc1
  s_waitcnt vmcnt(23)
  v_mfma_f32_16x16x32_bf16 v[72:75], v[188:191], a[160:163], v[72:75]
  v_mfma_f32_16x16x32_bf16 v[76:79], v[188:191], a[164:167], v[76:79]
  v_mfma_f32_16x16x32_bf16 v[80:83], v[188:191], a[168:171], v[80:83]
  v_mfma_f32_16x16x32_bf16 v[84:87], v[188:191], a[172:175], v[84:87]
  buffer_load_dwordx4 v[188:191], v1, s[44:47], s38 offen offset:1024 sc1
  s_add_u32 s38, s38, 4096
  s_waitcnt vmcnt(23)
  v_mfma_f32_16x16x32_bf16 v[88:91], v[192:195], a[160:163], v[88:91]
  v_mfma_f32_16x16x32_bf16 v[92:95], v[192:195], a[164:167], v[92:95]
  v_mfma_f32_16x16x32_bf16 v[96:99], v[192:195], a[168:171], v[96:99]
  v_mfma_f32_16x16x32_bf16 v[100:103], v[192:195], a[172:175], v[100:103]
  buffer_load_dwordx4 v[192:195], v1, s[44:47], s39 offen offset:0 sc1
  s_waitcnt vmcnt(23)
  v_mfma_f32_16x16x32_bf16 v[104:107], v[196:199], a[160:163], v[104:107]
  v_mfma_f32_16x16x32_bf16 v[108:111], v[196:199], a[164:167], v[108:111]
  v_mfma_f32_16x16x32_bf16 v[112:115], v[196:199], a[168:171], v[112:115]
  v_mfma_f32_16x16x32_bf16 v[116:119], v[196:199], a[172:175], v[116:119]
  buffer_load_dwordx4 v[196:199], v1, s[44:47], s39 offen offset:1024 sc1
  s_add_u32 s39, s39, 4096
  s_waitcnt vmcnt(23)
  v_mfma_f32_16x16x32_bf16 v[56:59], v[200:203], a[176:179], v[56:59]
  v_mfma_f32_16x16x32_bf16 v[60:63], v[200:203], a[180:183], v[60:63]
  v_mfma_f32_16x16x32_bf16 v[64:67], v[200:203], a[184:187], v[64:67]
  v_mfma_f32_16x16x32_bf16 v[68:71], v[200:203], a[188:191], v[68:71]
  buffer_load_dwordx4 v[200:203], v1, s[44:47], s38 offen offset:0 sc1
  s_waitcnt vmcnt(23)
  v_mfma_f32_16x16x32_bf16 v[72:75], v[204:207], a[176:179], v[72:75]
  v_mfma_f32_16x16x32_bf16 v[76:79], v[204:207], a[180:183], v[76:79]
  v_mfma_f32_16x16x32_bf16 v[80:83], v[204:207], a[184:187], v[80:83]
  v_mfma_f32_16x16x32_bf16 v[84:87], v[204:207], a[188:191], v[84:87]
  buffer_load_dwordx4 v[204:207], v1, s[44:47], s38 offen offset:1024 sc1
  s_add_u32 s38, s38, 4096
  s_waitcnt vmcnt(23)
  v_mfma_f32_16x16x32_bf16 v[88:91], v[208:211], a[176:179], v[88:91]
  v_mfma_f32_16x16x32_bf16 v[92:95], v[208:211], a[180:183], v[92:95]
  v_mfma_f32_16x16x32_bf16 v[96:99], v[208:211], a[184:187], v[96:99]
  v_mfma_f32_16x16x32_bf16 v[100:103], v[208:211], a[188:191], v[100:103]
  buffer_load_dwordx4 v[208:211], v1, s[44:47], s39 offen offset:0 sc1
  s_waitcnt vmcnt(23)
  v_mfma_f32_16x16x32_bf16 v[104:107], v[212:215], a[176:179], v[104:107]
  v_mfma_f32_16x16x32_bf16 v[108:111], v[212:215], a[180:183], v[108:111]
  v_mfma_f32_16x16x32_bf16 v[112:115], v[212:215], a[184:187], v[112:115]
  v_mfma_f32_16x16x32_bf16 v[116:119], v[212:215], a[188:191], v[116:119]
  buffer_load_dwordx4 v[212:215], v1, s[44:47], s39 offen offset:1024 sc1
  s_add_u32 s39, s39, 4096
  s_waitcnt vmcnt(23)
  v_mfma_f32_16x16x32_bf16 v[56:59], v[120:123], a[192:195], v[56:59]
  v_mfma_f32_16x16x32_bf16 v[60:63], v[120:123], a[196:199], v[60:63]
  v_mfma_f32_16x16x32_bf16 v[64:67], v[120:123], a[200:203], v[64:67]
  v_mfma_f32_16x16x32_bf16 v[68:71], v[120:123], a[204:207], v[68:71]
  buffer_load_dwordx4 v[120:123], v1, s[44:47], s38 offen offset:0 sc1
  s_waitcnt vmcnt(23)
  v_mfma_f32_16x16x32_bf16 v[72:75], v[124:127], a[192:195], v[72:75]
  v_mfma_f32_16x16x32_bf16 v[76:79], v[124:127], a[196:199], v[76:79]
  v_mfma_f32_16x16x32_bf16 v[80:83], v[124:127], a[200:203], v[80:83]
  v_mfma_f32_16x16x32_bf16 v[84:87], v[124:127], a[204:207], v[84:87]
  buffer_load_dwordx4 v[124:127], v1, s[44:47], s38 offen offset:1024 sc1
  s_add_u32 s38, s38, 4096
  s_waitcnt vmcnt(23)
  v_mfma_f32_16x16x32_bf16 v[88:91], v[128:131], a[192:195], v[88:91]
  v_mfma_f32_16x16x32_bf16 v[92:95], v[128:131], a[196:199], v[92:95]
  v_mfma_f32_16x16x32_bf16 v[96:99], v[128:131], a[200:203], v[96:99]
  v_mfma_f32_16x16x32_bf16 v[100:103], v[128:131], a[204:207], v[100:103]
  buffer_load_dwordx4 v[128:131], v1, s[44:47], s39 offen offset:0 sc1
  s_waitcnt vmcnt(23)
  v_mfma_f32_16x16x32_bf16 v[104:107], v[132:135], a[192:195], v[104:107]
  v_mfma_f32_16x16x32_bf16 v[108:111], v[132:135], a[196:199], v[108:111]
  v_mfma_f32_16x16x32_bf16 v[112:115], v[132:135], a[200:203], v[112:115]
  v_mfma_f32_16x16x32_bf16 v[116:119], v[132:135], a[204:207], v[116:119]
  buffer_load_dwordx4 v[132:135], v1, s[44:47], s39 offen offset:1024 sc1
  s_add_u32 s39, s39, 4096
  s_waitcnt vmcnt(23)
  v_mfma_f32_16x16x32_bf16 v[56:59], v[136:139], a[208:211], v[56:59]
  v_mfma_f32_16x16x32_bf16 v[60:63], v[136:139], a[212:215], v[60:63]
  v_mfma_f32_16x16x32_bf16 v[64:67], v[136:139], a[216:219], v[64:67]
  v_mfma_f32_16x16x32_bf16 v[68:71], v[136:139], a[220:223], v[68:71]
  buffer_load_dwordx4 v[136:139], v1, s[44:47], s38 offen offset:0 sc1
  s_waitcnt vmcnt(23)
  v_mfma_f32_16x16x32_bf16 v[72:75], v[140:143], a[208:211], v[72:75]
  v_mfma_f32_16x16x32_bf16 v[76:79], v[140:143], a[212:215], v[76:79]
  v_mfma_f32_16x16x32_bf16 v[80:83], v[140:143], a[216:219], v[80:83]
  v_mfma_f32_16x16x32_bf16 v[84:87], v[140:143], a[220:223], v[84:87]
  buffer_load_dwordx4 v[140:143], v1, s[44:47], s38 offen offset:1024 sc1
  s_add_u32 s38, s38, 4096
  s_waitcnt vmcnt(23)
  v_mfma_f32_16x16x32_bf16 v[88:91], v[144:147], a[208:211], v[88:91]
  v_mfma_f32_16x16x32_bf16 v[92:95], v[144:147], a[212:215], v[92:95]
  v_mfma_f32_16x16x32_bf16 v[96:99], v[144:147], a[216:219], v[96:99]
  v_mfma_f32_16x16x32_bf16 v[100:103], v[144:147], a[220:223], v[100:103]
  buffer_load_dwordx4 v[144:147], v1, s[44:47], s39 offen offset:0 sc1
  s_waitcnt vmcnt(23)
  v_mfma_f32_16x16x32_bf16 v[104:107], v[148:151], a[208:211], v[104:107]
  v_mfma_f32_16x16x32_bf16 v[108:111], v[148:151], a[212:215], v[108:111]
  v_mfma_f32_16x16x32_bf16 v[112:115], v[148:151], a[216:219], v[112:115]
  v_mfma_f32_16x16x32_bf16 v[116:119], v[148:151], a[220:223], v[116:119]
  buffer_load_dwordx4 v[148:151], v1, s[44:47], s39 offen offset:1024 sc1
  s_add_u32 s39, s39, 4096
  s_waitcnt vmcnt(20)
  v_mfma_f32_16x16x32_bf16 v[56:59], v[16:19], v[152:155], v[56:59]
  v_mfma_f32_16x16x32_bf16 v[60:63], v[16:19], v[156:159], v[60:63]
  v_mfma_f32_16x16x32_bf16 v[64:67], v[16:19], v[160:163], v[64:67]
  v_mfma_f32_16x16x32_bf16 v[68:71], v[16:19], v[164:167], v[68:71]
  v_mfma_f32_16x16x32_bf16 v[72:75], v[20:23], v[152:155], v[72:75]
  v_mfma_f32_16x16x32_bf16 v[76:79], v[20:23], v[156:159], v[76:79]
  v_mfma_f32_16x16x32_bf16 v[80:83], v[20:23], v[160:163], v[80:83]
  v_mfma_f32_16x16x32_bf16 v[84:87], v[20:23], v[164:167], v[84:87]
  v_mfma_f32_16x16x32_bf16 v[88:91], v[24:27], v[152:155], v[88:91]
  v_mfma_f32_16x16x32_bf16 v[92:95], v[24:27], v[156:159], v[92:95]
  v_mfma_f32_16x16x32_bf16 v[96:99], v[24:27], v[160:163], v[96:99]
  v_mfma_f32_16x16x32_bf16 v[100:103], v[24:27], v[164:167], v[100:103]
  v_mfma_f32_16x16x32_bf16 v[104:107], v[28:31], v[152:155], v[104:107]
  v_mfma_f32_16x16x32_bf16 v[108:111], v[28:31], v[156:159], v[108:111]
  v_mfma_f32_16x16x32_bf16 v[112:115], v[28:31], v[160:163], v[112:115]
  v_mfma_f32_16x16x32_bf16 v[116:119], v[28:31], v[164:167], v[116:119]
  buffer_load_dwordx4 v[152:155], v1, s[44:47], s38 offen offset:0 sc1
  buffer_load_dwordx4 v[156:159], v1, s[44:47], s38 offen offset:1024 sc1
  s_waitcnt vmcnt(18)
  v_mfma_f32_16x16x32_bf16 v[56:59], v[32:35], v[168:171], v[56:59]
  v_mfma_f32_16x16x32_bf16 v[60:63], v[32:35], v[172:175], v[60:63]
  v_mfma_f32_16x16x32_bf16 v[64:67], v[32:35], v[176:179], v[64:67]
  v_mfma_f32_16x16x32_bf16 v[68:71], v[32:35], v[180:183], v[68:71]
  buffer_load_dwordx4 v[160:163], v1, s[44:47], s39 offen offset:0 sc1
  v_mfma_f32_16x16x32_bf16 v[72:75], v[36:39], v[168:171], v[72:75]
  v_mfma_f32_16x16x32_bf16 v[76:79], v[36:39], v[172:175], v[76:79]
  v_mfma_f32_16x16x32_bf16 v[80:83], v[36:39], v[176:179], v[80:83]
  v_mfma_f32_16x16x32_bf16 v[84:87], v[36:39], v[180:183], v[84:87]
  buffer_load_dwordx4 v[164:167], v1, s[44:47], s39 offen offset:1024 sc1
  v_mfma_f32_16x16x32_bf16 v[88:91], v[40:43], v[168:171], v[88:91]
  v_mfma_f32_16x16x32_bf16 v[92:95], v[40:43], v[172:175], v[92:95]
  v_mfma_f32_16x16x32_bf16 v[96:99], v[40:43], v[176:179], v[96:99]
  v_mfma_f32_16x16x32_bf16 v[100:103], v[40:43], v[180:183], v[100:103]
  v_mfma_f32_16x16x32_bf16 v[104:107], v[44:47], v[168:171], v[104:107]
  v_mfma_f32_16x16x32_bf16 v[108:111], v[44:47], v[172:175], v[108:111]
  v_mfma_f32_16x16x32_bf16 v[112:115], v[44:47], v[176:179], v[112:115]
  v_mfma_f32_16x16x32_bf16 v[116:119], v[44:47], v[180:183], v[116:119]
  s_waitcnt vmcnt(16)
  v_mfma_f32_16x16x32_bf16 v[56:59], v[48:51], v[184:187], v[56:59]
  v_mfma_f32_16x16x32_bf16 v[60:63], v[48:51], v[188:191], v[60:63]
  v_mfma_f32_16x16x32_bf16 v[64:67], v[48:51], v[192:195], v[64:67]
  v_mfma_f32_16x16x32_bf16 v[68:71], v[48:51], v[196:199], v[68:71]
  v_mfma_f32_16x16x32_bf16 v[72:75], v[52:55], v[184:187], v[72:75]
  v_mfma_f32_16x16x32_bf16 v[76:79], v[52:55], v[188:191], v[76:79]
  v_mfma_f32_16x16x32_bf16 v[80:83], v[52:55], v[192:195], v[80:83]
  v_mfma_f32_16x16x32_bf16 v[84:87], v[52:55], v[196:199], v[84:87]
  v_mfma_f32_16x16x32_bf16 v[88:91], v[216:219], v[184:187], v[88:91]
  v_mfma_f32_16x16x32_bf16 v[92:95], v[216:219], v[188:191], v[92:95]
  v_mfma_f32_16x16x32_bf16 v[96:99], v[216:219], v[192:195], v[96:99]
  v_mfma_f32_16x16x32_bf16 v[100:103], v[216:219], v[196:199], v[100:103]
  v_mfma_f32_16x16x32_bf16 v[104:107], v[220:223], v[184:187], v[104:107]
  v_mfma_f32_16x16x32_bf16 v[108:111], v[220:223], v[188:191], v[108:111]
  v_mfma_f32_16x16x32_bf16 v[112:115], v[220:223], v[192:195], v[112:115]
  v_mfma_f32_16x16x32_bf16 v[116:119], v[220:223], v[196:199], v[116:119]
  s_waitcnt vmcnt(12)
  v_mfma_f32_16x16x32_bf16 v[56:59], v[224:227], v[200:203], v[56:59]
  v_mfma_f32_16x16x32_bf16 v[60:63], v[224:227], v[204:207], v[60:63]
  v_mfma_f32_16x16x32_bf16 v[64:67], v[224:227], v[208:211], v[64:67]
  v_mfma_f32_16x16x32_bf16 v[68:71], v[224:227], v[212:215], v[68:71]
  v_mfma_f32_16x16x32_bf16 v[72:75], v[228:231], v[200:203], v[72:75]
  v_mfma_f32_16x16x32_bf16 v[76:79], v[228:231], v[204:207], v[76:79]
  v_mfma_f32_16x16x32_bf16 v[80:83], v[228:231], v[208:211], v[80:83]
  v_mfma_f32_16x16x32_bf16 v[84:87], v[228:231], v[212:215], v[84:87]
  v_mfma_f32_16x16x32_bf16 v[88:91], v[232:235], v[200:203], v[88:91]
  v_mfma_f32_16x16x32_bf16 v[92:95], v[232:235], v[204:207], v[92:95]
  v_mfma_f32_16x16x32_bf16 v[96:99], v[232:235], v[208:211], v[96:99]
  v_mfma_f32_16x16x32_bf16 v[100:103], v[232:235], v[212:215], v[100:103]
  v_mfma_f32_16x16x32_bf16 v[104:107], v[236:239], v[200:203], v[104:107]
  v_mfma_f32_16x16x32_bf16 v[108:111], v[236:239], v[204:207], v[108:111]
  v_mfma_f32_16x16x32_bf16 v[112:115], v[236:239], v[208:211], v[112:115]
  v_mfma_f32_16x16x32_bf16 v[116:119], v[236:239], v[212:215], v[116:119]
  s_waitcnt vmcnt(8)
  v_mfma_f32_16x16x32_bf16 v[56:59], a[0:3], v[120:123], v[56:59]
  v_mfma_f32_16x16x32_bf16 v[60:63], a[0:3], v[124:127], v[60:63]
  v_mfma_f32_16x16x32_bf16 v[64:67], a[0:3], v[128:131], v[64:67]
  v_mfma_f32_16x16x32_bf16 v[68:71], a[0:3], v[132:135], v[68:71]
  v_mfma_f32_16x16x32_bf16 v[72:75], a[4:7], v[120:123], v[72:75]
  v_mfma_f32_16x16x32_bf16 v[76:79], a[4:7], v[124:127], v[76:79]
  v_mfma_f32_16x16x32_bf16 v[80:83], a[4:7], v[128:131], v[80:83]
  v_mfma_f32_16x16x32_bf16 v[84:87], a[4:7], v[132:135], v[84:87]
  v_mfma_f32_16x16x32_bf16 v[88:91], a[8:11], v[120:123], v[88:91]
  v_mfma_f32_16x16x32_bf16 v[92:95], a[8:11], v[124:127], v[92:95]
  v_mfma_f32_16x16x32_bf16 v[96:99], a[8:11], v[128:131], v[96:99]
  v_mfma_f32_16x16x32_bf16 v[100:103], a[8:11], v[132:135], v[100:103]
  v_mfma_f32_16x16x32_bf16 v[104:107], a[12:15], v[120:123], v[104:107]
  v_mfma_f32_16x16x32_bf16 v[108:111], a[12:15], v[124:127], v[108:111]
  v_mfma_f32_16x16x32_bf16 v[112:115], a[12:15], v[128:131], v[112:115]
  v_mfma_f32_16x16x32_bf16 v[116:119], a[12:15], v[132:135], v[116:119]
  s_waitcnt vmcnt(4)
  v_mfma_f32_16x16x32_bf16 v[56:59], a[224:227], v[136:139], v[56:59]
  v_mfma_f32_16x16x32_bf16 v[60:63], a[224:227], v[140:143], v[60:63]
  v_mfma_f32_16x16x32_bf16 v[64:67], a[224:227], v[144:147], v[64:67]
  v_mfma_f32_16x16x32_bf16 v[68:71], a[224:227], v[148:151], v[68:71]
  v_mfma_f32_16x16x32_bf16 v[72:75], a[228:231], v[136:139], v[72:75]
  v_mfma_f32_16x16x32_bf16 v[76:79], a[228:231], v[140:143], v[76:79]
  v_mfma_f32_16x16x32_bf16 v[80:83], a[228:231], v[144:147], v[80:83]
  v_mfma_f32_16x16x32_bf16 v[84:87], a[228:231], v[148:151], v[84:87]
  v_mfma_f32_16x16x32_bf16 v[88:91], a[232:235], v[136:139], v[88:91]
  v_mfma_f32_16x16x32_bf16 v[92:95], a[232:235], v[140:143], v[92:95]
  v_mfma_f32_16x16x32_bf16 v[96:99], a[232:235], v[144:147], v[96:99]
  v_mfma_f32_16x16x32_bf16 v[100:103], a[232:235], v[148:151], v[100:103]
  v_mfma_f32_16x16x32_bf16 v[104:107], a[236:239], v[136:139], v[104:107]
  v_mfma_f32_16x16x32_bf16 v[108:111], a[236:239], v[140:143], v[108:111]
  v_mfma_f32_16x16x32_bf16 v[112:115], a[236:239], v[144:147], v[112:115]
  v_mfma_f32_16x16x32_bf16 v[116:119], a[236:239], v[148:151], v[116:119]
  s_waitcnt vmcnt(0)
  v_mfma_f32_16x16x32_bf16 v[56:59], a[240:243], v[152:155], v[56:59]
  v_mfma_f32_16x16x32_bf16 v[60:63], a[240:243], v[156:159], v[60:63]
  v_mfma_f32_16x16x32_bf16 v[64:67], a[240:243], v[160:163], v[64:67]
  v_mfma_f32_16x16x32_bf16 v[68:71], a[240:243], v[164:167], v[68:71]
  v_mfma_f32_16x16x32_bf16 v[72:75], a[244:247], v[152:155], v[72:75]
  v_mfma_f32_16x16x32_bf16 v[76:79], a[244:247], v[156:159], v[76:79]
  v_mfma_f32_16x16x32_bf16 v[80:83], a[244:247], v[160:163], v[80:83]
  v_mfma_f32_16x16x32_bf16 v[84:87], a[244:247], v[164:167], v[84:87]
  v_mfma_f32_16x16x32_bf16 v[88:91], a[248:251], v[152:155], v[88:91]
  v_mfma_f32_16x16x32_bf16 v[92:95], a[248:251], v[156:159], v[92:95]
  v_mfma_f32_16x16x32_bf16 v[96:99], a[248:251], v[160:163], v[96:99]
  v_mfma_f32_16x16x32_bf16 v[100:103], a[248:251], v[164:167], v[100:103]
  v_mfma_f32_16x16x32_bf16 v[104:107], a[252:255], v[152:155], v[104:107]
  v_mfma_f32_16x16x32_bf16 v[108:111], a[252:255], v[156:159], v[108:111]
  v_mfma_f32_16x16x32_bf16 v[112:115], a[252:255], v[160:163], v[112:115]
  v_mfma_f32_16x16x32_bf16 v[116:119], a[252:255], v[164:167], v[116:119]
  v_and_b32 v7, 15, v0
  v_lshrrev_b32 v8, 4, v0
  v_and_b32 v9, 7, v7
  v_xor_b32 v8, v8, v9
  v_lshlrev_b32 v8, 4, v8
  v_lshlrev_b32 v7, 7, v7
  v_add_u32 v8, v8, v7
  v_add_u32 v8, s84, v8
  v_xor_b32 v9, 64, v8
  v_lshrrev_b32 v7, 3, v0
  v_and_b32 v11, 7, v0
  v_xor_b32 v10, v11, v7
  v_lshlrev_b32 v10, 4, v10
  v_lshlrev_b32 v6, 7, v7
  v_add_u32 v10, v10, v6
  v_add_u32 v10, s84, v10
  v_mul_u32_u24 v7, 1792, v7
  v_lshlrev_b32 v11, 4, v11
  v_add_u32 v11, v11, v7
  s_lshl_b32 s79, s67, 6
  s_lshl_b32 s80, s66, 5
  s_add_u32 s79, s79, s80
  s_mul_i32 s79, s79, 1792
  s_lshl_b32 s80, s68, 6
  s_lshl_b32 s81, s65, 5
  s_add_u32 s80, s80, s81
  s_lshl_b32 s80, s80, 2
  s_add_u32 s76, s79, s80
  s_xor_b32 s79, s64, 1
  s_mul_i32 s79, s79, 12288
  s_add_u32 s79, s79, 0
  v_add_u32 v7, s79, v1
  ds_write_b128 v7, v[64:67] offset:0
  ds_write_b128 v7, v[68:71] offset:1024
  ds_write_b128 v7, v[80:83] offset:2048
  ds_write_b128 v7, v[84:87] offset:3072
  s_xor_b32 s79, s64, 2
  s_mul_i32 s79, s79, 12288
  s_add_u32 s79, s79, 4096
  v_add_u32 v7, s79, v1
  ds_write_b128 v7, v[88:91] offset:0
  ds_write_b128 v7, v[92:95] offset:1024
  ds_write_b128 v7, v[104:107] offset:2048
  ds_write_b128 v7, v[108:111] offset:3072
  s_xor_b32 s79, s64, 3
  s_mul_i32 s79, s79, 12288
  s_add_u32 s79, s79, 8192
  v_add_u32 v7, s79, v1
  ds_write_b128 v7, v[96:99] offset:0
  ds_write_b128 v7, v[100:103] offset:1024
  ds_write_b128 v7, v[112:115] offset:2048
  ds_write_b128 v7, v[116:119] offset:3072
  s_waitcnt lgkmcnt(0)
  s_barrier
  s_mul_i32 s79, s64, 12288
  v_add_u32 v7, s79, v1
  ds_read_b128 v[120:123], v7 offset:0
  ds_read_b128 v[124:127], v7 offset:1024
  ds_read_b128 v[128:131], v7 offset:2048
  ds_read_b128 v[132:135], v7 offset:3072
  ds_read_b128 v[136:139], v7 offset:4096
  ds_read_b128 v[140:143], v7 offset:5120
  ds_read_b128 v[144:147], v7 offset:6144
  ds_read_b128 v[148:151], v7 offset:7168
  ds_read_b128 v[152:155], v7 offset:8192
  ds_read_b128 v[156:159], v7 offset:9216
  ds_read_b128 v[160:163], v7 offset:10240
  ds_read_b128 v[164:167], v7 offset:11264
  s_waitcnt lgkmcnt(8)
  v_pk_add_f32 v[56:57], v[56:57], v[120:121]
  v_pk_add_f32 v[58:59], v[58:59], v[122:123]
  v_pk_add_f32 v[60:61], v[60:61], v[124:125]
  v_pk_add_f32 v[62:63], v[62:63], v[126:127]
  v_pk_add_f32 v[72:73], v[72:73], v[128:129]
  v_pk_add_f32 v[74:75], v[74:75], v[130:131]
  v_pk_add_f32 v[76:77], v[76:77], v[132:133]
  v_pk_add_f32 v[78:79], v[78:79], v[134:135]
  s_waitcnt lgkmcnt(4)
  v_pk_add_f32 v[56:57], v[56:57], v[136:137]
  v_pk_add_f32 v[58:59], v[58:59], v[138:139]
  v_pk_add_f32 v[60:61], v[60:61], v[140:141]
  v_pk_add_f32 v[62:63], v[62:63], v[142:143]
  v_pk_add_f32 v[72:73], v[72:73], v[144:145]
  v_pk_add_f32 v[74:75], v[74:75], v[146:147]
  v_pk_add_f32 v[76:77], v[76:77], v[148:149]
  v_pk_add_f32 v[78:79], v[78:79], v[150:151]
  s_waitcnt lgkmcnt(0)
  v_pk_add_f32 v[56:57], v[56:57], v[152:153]
  v_pk_add_f32 v[58:59], v[58:59], v[154:155]
  v_pk_add_f32 v[60:61], v[60:61], v[156:157]
  v_pk_add_f32 v[62:63], v[62:63], v[158:159]
  v_pk_add_f32 v[72:73], v[72:73], v[160:161]
  v_pk_add_f32 v[74:75], v[74:75], v[162:163]
  v_pk_add_f32 v[76:77], v[76:77], v[164:165]
  v_pk_add_f32 v[78:79], v[78:79], v[166:167]
  v_pk_add_f32 v[56:57], v[56:57], v[240:241]
  v_pk_add_f32 v[58:59], v[58:59], v[242:243]
  v_pk_add_f32 v[72:73], v[72:73], v[244:245]
  v_pk_add_f32 v[74:75], v[74:75], v[246:247]
  v_pk_add_f32 v[60:61], v[60:61], v[248:249]
  v_pk_add_f32 v[62:63], v[62:63], v[250:251]
  v_pk_add_f32 v[76:77], v[76:77], v[252:253]
  v_pk_add_f32 v[78:79], v[78:79], v[254:255]
  ds_write_b128 v8, v[56:59] offset:0
  ds_write_b128 v9, v[72:75] offset:0
  ds_write_b128 v8, v[60:63] offset:2048
  ds_write_b128 v9, v[76:79] offset:2048
  s_waitcnt lgkmcnt(0)
  ds_read_b128 v[120:123], v10 offset:0
  ds_read_b128 v[124:127], v10 offset:1024
  ds_read_b128 v[128:131], v10 offset:2048
  ds_read_b128 v[132:135], v10 offset:3072
  s_waitcnt lgkmcnt(3)
  buffer_store_dwordx4 v[120:123], v11, s[60:63], s76 offen sc1
  s_add_u32 s76, s76, 14336
  s_waitcnt lgkmcnt(2)
  buffer_store_dwordx4 v[124:127], v11, s[60:63], s76 offen sc1
  s_add_u32 s76, s76, 14336
  s_waitcnt lgkmcnt(1)
  buffer_store_dwordx4 v[128:131], v11, s[60:63], s76 offen sc1
  s_add_u32 s76, s76, 14336
  s_waitcnt lgkmcnt(0)
  buffer_store_dwordx4 v[132:135], v11, s[60:63], s76 offen sc1
L_exit:
  s_endpgm
L_code_end:

.section .rodata,"a"
.p2align 6
.amdhsa_kernel parallel_sum__ssm_conv_s5__mixer_token_mlp__prompt_kernel
  .amdhsa_next_free_vgpr 512
  .amdhsa_next_free_sgpr 102
  .amdhsa_accum_offset 256
  .amdhsa_group_segment_fixed_size 0
  .amdhsa_kernarg_size 136
  .amdhsa_user_sgpr_count 2
  .amdhsa_user_sgpr_kernarg_segment_ptr 1
  .amdhsa_system_sgpr_workgroup_id_x 1
  .amdhsa_float_denorm_mode_32 3
.end_amdhsa_kernel
```
